```python
import torch

def _softmax(x, axis=-1):
    return torch.softmax(x, dim=axis)
def _gelu(x):
    return torch.nn.functional.gelu(x, approximate="tanh")
def _silu(x):
    return torch.nn.functional.silu(x)
def _sigmoid(x):
    return torch.sigmoid(x)
def _layernorm(x, axis=-1, eps=1e-5):
    m = x.mean(dim=axis, keepdim=True)
    v = x.var(dim=axis, keepdim=True, unbiased=False)
    return (x - m) / torch.sqrt(v + eps)
def _scatter_add(tgt, idx, src, axis=0):
    return tgt.clone().index_add_(axis, idx, src)
def _segment_sum(src, seg, n):
    out = torch.zeros((n,) + src.shape[1:], dtype=src.dtype)
    return out.index_add_(0, seg, src)
def _pad(x, pw):
    flat = tuple(v for pair in reversed(pw) for v in pair)
    return torch.nn.functional.pad(x, flat)

kernel_name = 'gated_mix__mha_block__ssm_conv_h3__prompt'

def setup_inputs():

    _w = (lambda a: (lambda t: t.to(torch.bfloat16) if t.is_floating_point() else t)(torch.as_tensor(a)))
    def _A_setup():
        B, S, D, H = 1, 2048, 576, 32
        return {
            "x": _w((lambda *s: torch.randn(*s, dtype=torch.bfloat16) * 0.05)(B, S, D)),
            "wqkv": _w((lambda *s: torch.randn(*s, dtype=torch.bfloat16) * 0.8)(D, 3 * D)),
            "wo": _w((lambda *s: torch.randn(*s, dtype=torch.bfloat16) * 0.05)(D, D)),
        }
    _A_in = _A_setup()

    def _B_setup():
        B, S, D = 1, 2048, 576
        ks = 4
        return {
            "q": _w((lambda *s: torch.randn(*s, dtype=torch.bfloat16) * 0.05)(B, S, D)),
            "k": _w((lambda *s: torch.randn(*s, dtype=torch.bfloat16) * 0.4)(B, S, D)),
            "v": _w((lambda *s: torch.randn(*s, dtype=torch.bfloat16) * 0.4)(B, S, D)),
            "shift_k": _w((lambda *s: torch.randn(*s, dtype=torch.bfloat16) * 0.4)(D, ks) * 0.5),
            "ssm_k": _w((lambda *s: torch.randn(*s, dtype=torch.bfloat16) * 1.6)(D, S) * (1.0 / S ** 0.5)),
            "ssm_D": _w((lambda *s: torch.randn(*s, dtype=torch.bfloat16) * 0.4)(D)),
        }
    _B_in = _B_setup()

    return {
        "A_x": _A_in["x"],
        "A_wqkv": _A_in["wqkv"],
        "A_wo": _A_in["wo"],
        "B_q": _B_in["q"],
        "B_k": _B_in["k"],
        "B_v": _B_in["v"],
        "B_shift_k": _B_in["shift_k"],
        "B_ssm_k": _B_in["ssm_k"],
        "B_ssm_D": _B_in["ssm_D"],
        "gate_w": _w((lambda *s: torch.randn(*s, dtype=torch.bfloat16) * 0.05)(576) * 16.0),
    }

def reference(A_x, A_wqkv, A_wo, B_q, B_k, B_v, B_shift_k, B_ssm_k, B_ssm_D, gate_w):
    def _A_ref(x, wqkv, wo):
        B, S, D = x.shape
        H = 32
        Dh = D // H
        qkv = (lambda x, *d: x.permute(*d))((x @ wqkv).reshape(B, S, 3, H, Dh), 2, 0, 3, 1, 4)
        q, k, v = qkv[0], qkv[1], qkv[2]
        scores = torch.einsum("bhqd,bhkd->bhqk", q, k) * (Dh ** -0.5)
        p = _softmax(scores, axis=-1)
        o = torch.einsum("bhqk,bhkd->bhqd", p, v)
        return (lambda x, *d: x.permute(*d))(o, 0, 2, 1, 3).reshape(B, S, D) @ wo

    def _B_ref(q, k, v, shift_k, ssm_k, ssm_D):
        B, S, D = q.shape
        ks = shift_k.shape[-1]
        k_pad = _pad(k, ((0, 0), (ks - 1, 0), (0, 0)))
        k_shift = torch.zeros_like(k)
        for t in range(ks):
            k_shift = k_shift + k_pad[:, t:t + S, :] * shift_k[:, ks - 1 - t][None, None, :]
        kv = k_shift * v
        L = 2 * S
        kv_pad = _pad(kv, ((0, 0), (0, S), (0, 0)))
        kf_pad = _pad(ssm_k, ((0, 0), (0, S)))
        kv_f = (lambda x, axes=(-2,-1): torch.fft.rfft2(x.float(), dim=axes))(kv_pad[:, None, :, :], axes=(1, 2))
        kf_f = (lambda x, axes=(-2,-1): torch.fft.rfft2(x.float(), dim=axes))(kf_pad[:, None, :], axes=(1, 2))
        kf_f = (lambda x, *d: x.permute(*d))(kf_f, 1, 2, 0)
        y_f = kv_f * kf_f[None, :, :, :]
        y = (lambda x, s, axes=(-2,-1): torch.fft.irfft2(x, s=s, dim=axes).to(torch.bfloat16))(y_f, (1, L), axes=(1, 2))[:, 0, :S, :]
        y = y + kv * ssm_D[None, None, :]
        return q * y

    x = A_x
    g = _sigmoid((x * gate_w).sum(-1, keepdims=True))
    a = _A_ref(x, A_wqkv, A_wo)
    b = _B_ref(x, B_k, B_v, B_shift_k, B_ssm_k, B_ssm_D)
    return g * a + (1 - g) * b
```

```asm
; @launch grid=(256,1,1) block=(512,1,1) lds=163840
.amdgcn_target "amdgcn-amd-amdhsa--gfx950"
.text
.globl gated_mix__mha_block__ssm_conv_h3__prompt_kernel
.p2align 8
.type gated_mix__mha_block__ssm_conv_h3__prompt_kernel,@function
gated_mix__mha_block__ssm_conv_h3__prompt_kernel:
    s_cmp_ge_u32 s2, 256
    s_cbranch_scc1 L_end
    s_load_dwordx16 s[64:79], s[0:1], 0
    s_load_dwordx8 s[80:87], s[0:1], 64
    s_load_dwordx2 s[88:89], s[0:1], 96
    s_getpc_b64 s[90:91]
L_pcbase:
    v_lshrrev_b32 v2, 6, v0
    v_and_b32 v1, 63, v0
    v_readfirstlane_b32 s10, v2
    v_lshlrev_b32 v2, 7, v0
    v_cmp_gt_u32 vcc, L_end-L_pcbase, v2
    s_and_saveexec_b64 s[92:93], vcc
    s_cbranch_execz L_nocp
    global_load_dword v253, v2, s[90:91]
L_nocp:
    s_mov_b64 exec, s[92:93]
    s_and_b32 s12, s2, 7
    s_lshr_b32 s13, s2, 3
    s_lshr_b32 s14, s12, 1
    s_lshl_b32 s14, s14, 2
    s_and_b32 s15, s13, 3
    s_add_u32 s8, s14, s15
    s_and_b32 s14, s12, 1
    s_mul_i32 s14, s14, 6
    s_lshr_b32 s15, s13, 2
    s_add_u32 s14, s14, s15
    s_lshr_b32 s11, s14, 2
    s_and_b32 s9, s14, 3
    s_lshl_b32 s14, s13, 3
    s_add_u32 s14, s14, s12
    s_sub_u32 s33, s14, 192
    s_cmp_ge_u32 s13, 24
    s_cselect_b32 s32, 1, 0
    s_cselect_b32 s35, 3, 2
    s_mul_i32 s15, s33, 3
    s_lshl_b32 s34, s14, 1
    s_add_u32 s34, s34, 192
    s_cmp_ge_u32 s13, 24
    s_cselect_b32 s34, s15, s34
    s_and_b32 s12, s2, 7
    s_lshr_b32 s13, s2, 3
    s_lshr_b32 s14, s13, 3
    s_lshl_b32 s60, s12, 2
    s_add_u32 s60, s60, s14
    s_and_b32 s61, s13, 7
    s_and_b32 s12, s2, 7
    s_lshr_b32 s13, s2, 3
    s_lshr_b32 s14, s13, 2
    s_lshl_b32 s96, s12, 8
    s_lshl_b32 s14, s14, 5
    s_add_u32 s96, s96, s14
    s_and_b32 s97, s13, 3
    s_and_b32 s12, s2, 7
    s_lshr_b32 s13, s2, 3
    s_cmp_eq_u32 s32, 1
    s_mov_b32 s98, 110592
    s_cselect_b32 s98, 82432, s98
    s_cbranch_scc1 L_aux
    s_cmp_lt_u32 s10, 4
    s_cbranch_scc1 L_cons
    s_sub_u32 s12, s10, 4
    v_lshrrev_b32 v2, 3, v1
    v_and_b32 v3, 7, v1
    v_xor_b32 v3, v3, v2
    v_mul_u32_u24 v16, 1152, v2
    v_lshl_add_u32 v16, v3, 4, v16
    s_mul_i32 s54, s8, 147456
    s_mul_i32 s14, s12, 36864
    s_add_u32 s54, s54, s14
    s_mul_i32 s55, s11, 1152
    s_mul_i32 s14, s9, 288
    s_add_u32 s55, s55, s14
    s_lshl_b32 s56, s12, 12
    s_lshl_b32 s57, s12, 10
    s_add_u32 s57, s57, 16384
    s_lshl_b32 s14, s12, 6
    s_add_u32 s14, s14, 0
    v_add_u32 v2, s14, v1
    v_mul_u32_u24 v3, 3641, v2
    v_lshrrev_b32 v3, 16, v3
    v_mul_u32_u24 v4, 18, v3
    v_sub_u32 v4, v2, v4
    v_lshrrev_b32 v5, 2, v3
    v_lshrrev_b32 v6, 3, v3
    v_xor_b32 v5, v5, v6
    v_and_b32 v5, 1, v5
    v_mul_u32_u24 v5, 12, v5
    v_xor_b32 v3, v3, v5
    v_mul_u32_u24 v3, 3456, v3
    v_lshl_add_u32 v17, v4, 4, v3
    s_lshl_b32 s14, s12, 6
    s_add_u32 s14, s14, 256
    v_add_u32 v2, s14, v1
    v_mul_u32_u24 v3, 3641, v2
    v_lshrrev_b32 v3, 16, v3
    v_mul_u32_u24 v4, 18, v3
    v_sub_u32 v4, v2, v4
    v_lshrrev_b32 v5, 2, v3
    v_lshrrev_b32 v6, 3, v3
    v_xor_b32 v5, v5, v6
    v_and_b32 v5, 1, v5
    v_mul_u32_u24 v5, 12, v5
    v_xor_b32 v3, v3, v5
    v_mul_u32_u24 v3, 3456, v3
    v_lshl_add_u32 v18, v4, 4, v3
    s_lshl_b32 s14, s12, 6
    s_add_u32 s14, s14, 512
    v_add_u32 v2, s14, v1
    v_mul_u32_u24 v3, 3641, v2
    v_lshrrev_b32 v3, 16, v3
    v_mul_u32_u24 v4, 18, v3
    v_sub_u32 v4, v2, v4
    v_lshrrev_b32 v5, 2, v3
    v_lshrrev_b32 v6, 3, v3
    v_xor_b32 v5, v5, v6
    v_and_b32 v5, 1, v5
    v_mul_u32_u24 v5, 12, v5
    v_xor_b32 v3, v3, v5
    v_mul_u32_u24 v3, 3456, v3
    v_lshl_add_u32 v19, v4, 4, v3
    s_lshl_b32 s14, s12, 6
    s_add_u32 s14, s14, 768
    v_add_u32 v2, s14, v1
    v_mul_u32_u24 v3, 3641, v2
    v_lshrrev_b32 v3, 16, v3
    v_mul_u32_u24 v4, 18, v3
    v_sub_u32 v4, v2, v4
    v_lshrrev_b32 v5, 2, v3
    v_lshrrev_b32 v6, 3, v3
    v_xor_b32 v5, v5, v6
    v_and_b32 v5, 1, v5
    v_mul_u32_u24 v5, 12, v5
    v_xor_b32 v3, v3, v5
    v_mul_u32_u24 v3, 3456, v3
    v_lshl_add_u32 v20, v4, 4, v3
    s_lshl_b32 s14, s12, 6
    s_add_u32 s14, s14, 1024
    v_add_u32 v2, s14, v1
    v_mul_u32_u24 v3, 3641, v2
    v_lshrrev_b32 v3, 16, v3
    v_mul_u32_u24 v4, 18, v3
    v_sub_u32 v4, v2, v4
    v_lshrrev_b32 v5, 2, v3
    v_lshrrev_b32 v6, 3, v3
    v_xor_b32 v5, v5, v6
    v_and_b32 v5, 1, v5
    v_mul_u32_u24 v5, 12, v5
    v_xor_b32 v3, v3, v5
    v_mul_u32_u24 v3, 3456, v3
    v_lshl_add_u32 v21, v4, 4, v3
    s_cmp_ge_u32 s12, 2
    s_cselect_b64 vcc, -1, 0
    v_mov_b32 v2, 0x7f000000
    v_cndmask_b32 v21, v21, v2, vcc
    s_mov_b32 s53, 34816
    s_waitcnt lgkmcnt(0)
    s_mov_b32 s4, s88
    s_mov_b32 s5, s89
    s_mov_b32 s6, 15630336
    s_mov_b32 s7, 0x20000
    s_mov_b32 s44, s64
    s_mov_b32 s45, s65
    s_mov_b32 s46, 2359296
    s_mov_b32 s47, 0x20000
    s_mov_b32 s48, s66
    s_mov_b32 s49, s67
    s_mov_b32 s50, 1990656
    s_mov_b32 s51, 0x20000
    s_barrier
    s_mov_b32 s52, 0
L_pinit:
    s_add_u32 s14, s53, s56
    s_add_u32 m0, s14, 0
    s_add_u32 s15, s54, 0
    buffer_load_dwordx4 v16, s[44:47], s15 offen lds
    s_add_u32 m0, s14, 1024
    s_add_u32 s15, s54, 9216
    buffer_load_dwordx4 v16, s[44:47], s15 offen lds
    s_add_u32 m0, s14, 2048
    s_add_u32 s15, s54, 18432
    buffer_load_dwordx4 v16, s[44:47], s15 offen lds
    s_add_u32 m0, s14, 3072
    s_add_u32 s15, s54, 27648
    buffer_load_dwordx4 v16, s[44:47], s15 offen lds
    s_add_u32 s14, s53, s57
    s_add_u32 m0, s14, 0
    s_nop 0
    buffer_load_dwordx4 v17, s[48:51], s55 offen lds
    s_add_u32 m0, s14, 4096
    s_nop 0
    buffer_load_dwordx4 v18, s[48:51], s55 offen lds
    s_add_u32 m0, s14, 8192
    s_nop 0
    buffer_load_dwordx4 v19, s[48:51], s55 offen lds
    s_add_u32 m0, s14, 12288
    s_nop 0
    buffer_load_dwordx4 v20, s[48:51], s55 offen lds
    s_cmp_ge_u32 s12, 2
    s_cbranch_scc1 L_skipw0
    s_add_u32 m0, s14, 16384
    s_nop 0
    buffer_load_dwordx4 v21, s[48:51], s55 offen lds
L_skipw0:
    s_add_u32 s54, s54, 128
    s_add_u32 s55, s55, 221184
    s_add_u32 s53, s53, 34816
    s_cmp_eq_u32 s53, 139264
    s_cselect_b32 s53, 0, s53
    s_add_u32 s52, s52, 1
    s_cmp_lt_u32 s52, 2
    s_cbranch_scc1 L_pinit
    s_cmp_ge_u32 s12, 2
    s_cbranch_scc1 L_wc1
    s_waitcnt vmcnt(9)
L_wc1:
    s_cbranch_scc0 L_wd1
    s_waitcnt vmcnt(8)
L_wd1:
    s_barrier
    s_add_u32 s14, s53, s56
    s_add_u32 m0, s14, 0
    s_add_u32 s15, s54, 0
    buffer_load_dwordx4 v16, s[44:47], s15 offen lds
    s_add_u32 m0, s14, 1024
    s_add_u32 s15, s54, 9216
    buffer_load_dwordx4 v16, s[44:47], s15 offen lds
    s_add_u32 m0, s14, 2048
    s_add_u32 s15, s54, 18432
    buffer_load_dwordx4 v16, s[44:47], s15 offen lds
    s_add_u32 m0, s14, 3072
    s_add_u32 s15, s54, 27648
    buffer_load_dwordx4 v16, s[44:47], s15 offen lds
    s_add_u32 s14, s53, s57
    s_add_u32 m0, s14, 0
    s_nop 0
    buffer_load_dwordx4 v17, s[48:51], s55 offen lds
    s_add_u32 m0, s14, 4096
    s_nop 0
    buffer_load_dwordx4 v18, s[48:51], s55 offen lds
    s_add_u32 m0, s14, 8192
    s_nop 0
    buffer_load_dwordx4 v19, s[48:51], s55 offen lds
    s_add_u32 m0, s14, 12288
    s_nop 0
    buffer_load_dwordx4 v20, s[48:51], s55 offen lds
    s_cmp_ge_u32 s12, 2
    s_cbranch_scc1 L_skipw1
    s_add_u32 m0, s14, 16384
    s_nop 0
    buffer_load_dwordx4 v21, s[48:51], s55 offen lds
L_skipw1:
    s_add_u32 s54, s54, 128
    s_add_u32 s55, s55, 221184
    s_add_u32 s53, s53, 34816
    s_cmp_eq_u32 s53, 139264
    s_cselect_b32 s53, 0, s53
    s_add_u32 s52, s52, 1
    s_cmp_ge_u32 s12, 2
    s_cbranch_scc1 L_wc2
    s_waitcnt vmcnt(9)
L_wc2:
    s_cbranch_scc0 L_wd2
    s_waitcnt vmcnt(8)
L_wd2:
    s_barrier
L_ploop0:
    s_add_u32 s14, s53, s56
    s_add_u32 m0, s14, 0
    s_add_u32 s15, s54, 0
    buffer_load_dwordx4 v16, s[44:47], s15 offen lds
    s_add_u32 m0, s14, 1024
    s_add_u32 s15, s54, 9216
    buffer_load_dwordx4 v16, s[44:47], s15 offen lds
    s_add_u32 m0, s14, 2048
    s_add_u32 s15, s54, 18432
    buffer_load_dwordx4 v16, s[44:47], s15 offen lds
    s_add_u32 m0, s14, 3072
    s_add_u32 s15, s54, 27648
    buffer_load_dwordx4 v16, s[44:47], s15 offen lds
    s_add_u32 s14, s53, s57
    s_add_u32 m0, s14, 0
    s_nop 0
    buffer_load_dwordx4 v17, s[48:51], s55 offen lds
    s_add_u32 m0, s14, 4096
    s_nop 0
    buffer_load_dwordx4 v18, s[48:51], s55 offen lds
    s_add_u32 m0, s14, 8192
    s_nop 0
    buffer_load_dwordx4 v19, s[48:51], s55 offen lds
    s_add_u32 m0, s14, 12288
    s_nop 0
    buffer_load_dwordx4 v20, s[48:51], s55 offen lds
    s_cmp_ge_u32 s12, 2
    s_cbranch_scc1 L_skipw2
    s_add_u32 m0, s14, 16384
    s_nop 0
    buffer_load_dwordx4 v21, s[48:51], s55 offen lds
L_skipw2:
    s_add_u32 s54, s54, 128
    s_add_u32 s55, s55, 221184
    s_add_u32 s53, s53, 34816
    s_cmp_eq_u32 s53, 139264
    s_cselect_b32 s53, 0, s53
    s_add_u32 s52, s52, 1
    s_cmp_eq_u32 s52, 9
    s_cbranch_scc1 L_ptail
    s_cmp_ge_u32 s12, 2
    s_cbranch_scc1 L_wc3
    s_waitcnt vmcnt(9)
L_wc3:
    s_cbranch_scc0 L_wd3
    s_waitcnt vmcnt(8)
L_wd3:
    s_barrier
    s_branch L_ploop0
L_ptail:
    v_mov_b32 v2, 0
    s_mov_b32 s14, 15396864
    buffer_load_dword v254, v2, s[4:7], s14 offen sc1
    s_lshr_b32 s46, s2, 3
    s_lshl_b32 s46, s46, 8
    s_add_u32 s46, s46, 15368192
    v_lshlrev_b32 v2, 2, v1
    buffer_load_dword v30, v2, s[4:7], s46 offen sc1
    v_subrev_u32 v31, 256, v0
    s_mov_b32 s24, s78
    s_mov_b32 s25, s79
    s_mov_b32 s26, 2359296
    s_mov_b32 s27, 0x20000
    s_lshl_b32 s42, s34, 12
    s_sub_u32 s42, s42, 8
    v_lshlrev_b32 v2, 4, v31
    v_add_u32 v3, s42, v2
    v_add_u32 v4, 16, v3
    buffer_load_dwordx4 v[136:139], v3, s[24:27], 0 offen
    buffer_load_dwordx2 v[140:141], v4, s[24:27], 0 offen
    v_add_u32 v3, 4096, v3
    v_add_u32 v4, 16, v3
    buffer_load_dwordx4 v[142:145], v3, s[24:27], 0 offen
    buffer_load_dwordx2 v[146:147], v4, s[24:27], 0 offen
    v_add_u32 v3, 4096, v3
    s_cmp_eq_u32 s35, 3
    s_cbranch_scc0 L_hl_skipp
    v_add_u32 v4, 16, v3
    buffer_load_dwordx4 v[148:151], v3, s[24:27], 0 offen
    buffer_load_dwordx2 v[152:153], v4, s[24:27], 0 offen
L_hl_skipp:
    s_cmp_ge_u32 s12, 2
    s_cbranch_scc1 L_wc4
    s_waitcnt vmcnt(15)
L_wc4:
    s_cbranch_scc0 L_wd4
    s_waitcnt vmcnt(14)
L_wd4:
    s_barrier
    s_waitcnt vmcnt(6)
    s_barrier
    s_waitcnt vmcnt(0)
    v_readfirstlane_b32 s3, v254
    s_mul_i32 s3, s3, 0x0019660d
    s_add_u32 s3, s3, 0x3c6ef35f
    s_lshr_b32 s46, s2, 3
    s_lshl_b32 s46, s46, 8
    s_add_u32 s46, s46, 15368192
    v_cmp_ne_u32 vcc, s3, v30
    s_nop 3
    s_cmp_eq_u64 vcc, 0
    s_cbranch_scc1 L_f0ok
    v_lshlrev_b32 v2, 2, v1
    s_mov_b64 s[40:41], exec
    s_mov_b32 s42, 20000
L_poll1:
    buffer_load_dword v4, v2, s[4:7], s46 offen sc1
    s_waitcnt vmcnt(0)
    v_cmp_ne_u32 vcc, s3, v4
    s_nop 3
    s_cmp_eq_u64 vcc, 0
    s_cbranch_scc1 L_poll1_d
    s_sub_u32 s42, s42, 1
    s_cmp_lg_u32 s42, 0
    s_cbranch_scc1 L_poll1
L_poll1_d:
    s_mov_b64 exec, s[40:41]
L_poll1_e:
L_f0ok:
    v_subrev_u32 v7, 256, v0
    s_mul_i32 s43, s34, 7282
    s_lshr_b32 s43, s43, 20
    s_mul_i32 s48, s43, 144
    s_sub_u32 s48, s34, s48
    s_mul_i32 s43, s43, 9216
    s_lshl_b32 s48, s48, 6
    s_add_u32 s43, s43, s48
    s_add_u32 s43, s43, 9949184
    v_lshrrev_b32 v2, 2, v7
    v_and_b32 v3, 3, v7
    v_mul_u32_u24 v4, 36864, v2
    v_lshlrev_b32 v5, 4, v3
    v_sub_u32 v4, v5, v4
    v_add_u32 v4, s43, v4
    buffer_load_dwordx4 v[176:179], v4, s[4:7], 0 offen offset:0
    buffer_load_dwordx4 v[180:183], v4, s[4:7], 0 offen offset:64
    s_cmp_eq_u32 s35, 3
    s_cbranch_scc0 L_ul_skipp
    buffer_load_dwordx4 v[184:187], v4, s[4:7], 0 offen offset:128
L_ul_skipp:
    v_lshrrev_b32 v6, 2, v2
    v_lshrrev_b32 v5, 1, v3
    v_xor_b32 v6, v6, v5
    v_and_b32 v6, 1, v6
    v_and_b32 v5, 1, v3
    v_lshl_add_u32 v6, v5, 1, v6
    v_lshlrev_b32 v6, 4, v6
    v_lshl_add_u32 v6, v2, 6, v6
    s_add_u32 s48, s98, 16640
    v_add_u32 v6, s48, v6
    v_mov_b32 v24, 0
    v_mov_b32 v25, 0
    v_mov_b32 v26, 0
    v_mov_b32 v27, 0
    v_cmp_gt_u32 vcc, 60, v7
    s_and_saveexec_b64 s[44:45], vcc
    ds_write_b128 v6, v[24:27] offset:4096
    ds_write_b128 v6, v[24:27] offset:27136
    s_cmp_eq_u32 s35, 3
    s_cbranch_scc0 L_uzp
    ds_write_b128 v6, v[24:27] offset:50176
L_uzp:
    s_mov_b64 exec, s[44:45]
    v_mov_b32 v29, v6
    v_mov_b32 v156, 0
    v_mov_b32 v157, 0
    v_mov_b32 v158, 0
    v_mov_b32 v159, 0
    v_lshrrev_b32 v2, 2, v31
    v_mul_u32_u24 v3, 4160, v2
    v_and_b32 v5, 3, v31
    v_lshl_add_u32 v3, v5, 4, v3
    v_add_u32 v3, s98, v3
    v_cmp_gt_u32 vcc, 16, v31
    s_and_saveexec_b64 s[56:57], vcc
    ds_write_b128 v3, v[156:159] offset:0
    ds_write_b128 v3, v[156:159] offset:23040
    s_cmp_eq_u32 s35, 3
    s_cbranch_scc0 L_hzp
    ds_write_b128 v3, v[156:159] offset:46080
L_hzp:
    s_mov_b64 exec, s[56:57]
    v_lshlrev_b32 v2, 4, v31
    v_add_u32 v2, s98, v2
    v_cmp_ne_u32 vcc, 0, v31
    v_cndmask_b32 v136, 0, v136, vcc
    v_cndmask_b32 v137, 0, v137, vcc
    v_alignbit_b32 v156, v137, v136, 16
    v_alignbit_b32 v157, v138, v137, 16
    v_alignbit_b32 v158, v139, v138, 16
    v_alignbit_b32 v159, v140, v139, 16
    v_alignbit_b32 v160, v141, v140, 16
    ds_write_b128 v2, v[156:159] offset:64
    v_mov_b32 v164, v137
    v_mov_b32 v165, v138
    v_mov_b32 v166, v139
    v_mov_b32 v167, v140
    v_mov_b32 v168, v157
    v_mov_b32 v169, v158
    v_mov_b32 v170, v159
    v_mov_b32 v171, v160
    ds_write_b128 v2, v[164:167] offset:4224
    ds_write_b128 v2, v[168:171] offset:8384
    ds_write_b128 v2, v[138:141] offset:12544
    v_cndmask_b32 v142, 0, v142, vcc
    v_cndmask_b32 v143, 0, v143, vcc
    v_alignbit_b32 v156, v143, v142, 16
    v_alignbit_b32 v157, v144, v143, 16
    v_alignbit_b32 v158, v145, v144, 16
    v_alignbit_b32 v159, v146, v145, 16
    v_alignbit_b32 v160, v147, v146, 16
    ds_write_b128 v2, v[156:159] offset:23104
    v_mov_b32 v164, v143
    v_mov_b32 v165, v144
    v_mov_b32 v166, v145
    v_mov_b32 v167, v146
    v_mov_b32 v168, v157
    v_mov_b32 v169, v158
    v_mov_b32 v170, v159
    v_mov_b32 v171, v160
    ds_write_b128 v2, v[164:167] offset:27264
    ds_write_b128 v2, v[168:171] offset:31424
    ds_write_b128 v2, v[144:147] offset:35584
    s_cmp_eq_u32 s35, 3
    s_cbranch_scc0 L_hpp
    v_cndmask_b32 v148, 0, v148, vcc
    v_cndmask_b32 v149, 0, v149, vcc
    v_alignbit_b32 v156, v149, v148, 16
    v_alignbit_b32 v157, v150, v149, 16
    v_alignbit_b32 v158, v151, v150, 16
    v_alignbit_b32 v159, v152, v151, 16
    v_alignbit_b32 v160, v153, v152, 16
    ds_write_b128 v2, v[156:159] offset:46144
    v_mov_b32 v164, v149
    v_mov_b32 v165, v150
    v_mov_b32 v166, v151
    v_mov_b32 v167, v152
    v_mov_b32 v168, v157
    v_mov_b32 v169, v158
    v_mov_b32 v170, v159
    v_mov_b32 v171, v160
    ds_write_b128 v2, v[164:167] offset:50304
    ds_write_b128 v2, v[168:171] offset:54464
    ds_write_b128 v2, v[150:153] offset:58624
L_hpp:
    v_mov_b32 v6, v29
    s_waitcnt vmcnt(0)
    ds_write_b128 v6, v[176:179] offset:0
    ds_write_b128 v6, v[180:183] offset:23040
    s_cmp_eq_u32 s35, 3
    s_cbranch_scc0 L_uwp
    ds_write_b128 v6, v[184:187] offset:46080
L_uwp:
    s_branch L_afterA
L_cons:
    v_and_b32 v2, 15, v1
    v_lshrrev_b32 v3, 4, v1
    v_and_b32 v4, 7, v1
    v_xor_b32 v4, v4, v3
    s_lshl_b32 s14, s10, 12
    v_lshl_add_u32 v8, v2, 7, s14
    v_lshl_add_u32 v8, v4, 4, v8
    v_xor_b32 v9, 64, v8
    v_lshrrev_b32 v4, 2, v2
    v_and_b32 v5, 1, v3
    v_lshl_add_u32 v4, v5, 2, v4
    v_lshrrev_b32 v5, 1, v3
    v_lshl_add_u32 v4, v5, 4, v4
    v_mul_u32_u24 v4, 288, v4
    v_add_u32 v4, 16384, v4
    v_and_b32 v5, 3, v1
    v_lshl_add_u32 v10, v5, 3, v4
    v_mul_u32_u24 v6, 72, v5
    v_add3_u32 v11, v4, v6, 32
    v_mov_b32 v64, 0
    v_mov_b32 v65, 0
    v_mov_b32 v66, 0
    v_mov_b32 v67, 0
    v_mov_b32 v68, 0
    v_mov_b32 v69, 0
    v_mov_b32 v70, 0
    v_mov_b32 v71, 0
    v_mov_b32 v72, 0
    v_mov_b32 v73, 0
    v_mov_b32 v74, 0
    v_mov_b32 v75, 0
    v_mov_b32 v76, 0
    v_mov_b32 v77, 0
    v_mov_b32 v78, 0
    v_mov_b32 v79, 0
    v_mov_b32 v80, 0
    v_mov_b32 v81, 0
    v_mov_b32 v82, 0
    v_mov_b32 v83, 0
    v_mov_b32 v84, 0
    v_mov_b32 v85, 0
    v_mov_b32 v86, 0
    v_mov_b32 v87, 0
    v_mov_b32 v88, 0
    v_mov_b32 v89, 0
    v_mov_b32 v90, 0
    v_mov_b32 v91, 0
    v_mov_b32 v92, 0
    v_mov_b32 v93, 0
    v_mov_b32 v94, 0
    v_mov_b32 v95, 0
    v_mov_b32 v96, 0
    v_mov_b32 v97, 0
    v_mov_b32 v98, 0
    v_mov_b32 v99, 0
    v_mov_b32 v100, 0
    v_mov_b32 v101, 0
    v_mov_b32 v102, 0
    v_mov_b32 v103, 0
    v_mov_b32 v104, 0
    v_mov_b32 v105, 0
    v_mov_b32 v106, 0
    v_mov_b32 v107, 0
    v_mov_b32 v108, 0
    v_mov_b32 v109, 0
    v_mov_b32 v110, 0
    v_mov_b32 v111, 0
    v_mov_b32 v112, 0
    v_mov_b32 v113, 0
    v_mov_b32 v114, 0
    v_mov_b32 v115, 0
    v_mov_b32 v116, 0
    v_mov_b32 v117, 0
    v_mov_b32 v118, 0
    v_mov_b32 v119, 0
    v_mov_b32 v120, 0
    v_mov_b32 v121, 0
    v_mov_b32 v122, 0
    v_mov_b32 v123, 0
    v_mov_b32 v124, 0
    v_mov_b32 v125, 0
    v_mov_b32 v126, 0
    v_mov_b32 v127, 0
    v_mov_b32 v128, 0
    v_mov_b32 v129, 0
    v_mov_b32 v130, 0
    v_mov_b32 v131, 0
    v_mov_b32 v132, 0
    v_mov_b32 v133, 0
    v_mov_b32 v134, 0
    v_mov_b32 v135, 0
    s_mov_b32 s55, 155648
    s_cmp_eq_u32 s11, 0
    s_cselect_b32 s55, 73728, s55
    s_cmp_eq_u32 s11, 2
    s_movk_i32 s56, 72
    s_cselect_b32 s56, 80, s56
    s_lshl_b32 s57, s56, 4
    s_sub_u32 s57, s55, s57
    v_mov_b32 v61, v1
    v_lshlrev_b32 v176, 4, v1
    v_add_u32 v61, 64, v61
    v_add_u32 v177, 1024, v176
    v_cmp_le_u32 vcc, s56, v61
    v_subrev_u32 v63, s56, v61
    v_add_u32 v55, s57, v177
    v_cndmask_b32 v61, v61, v63, vcc
    v_cndmask_b32 v177, v177, v55, vcc
    v_add_u32 v61, 64, v61
    v_add_u32 v178, 1024, v177
    v_cmp_le_u32 vcc, s56, v61
    v_subrev_u32 v63, s56, v61
    v_add_u32 v55, s57, v178
    v_cndmask_b32 v61, v61, v63, vcc
    v_cndmask_b32 v178, v178, v55, vcc
    v_add_u32 v61, 64, v61
    v_add_u32 v179, 1024, v178
    v_cmp_le_u32 vcc, s56, v61
    v_subrev_u32 v63, s56, v61
    v_add_u32 v55, s57, v179
    v_cndmask_b32 v61, v61, v63, vcc
    v_cndmask_b32 v179, v179, v55, vcc
    v_add_u32 v61, 64, v61
    v_add_u32 v180, 1024, v179
    v_cmp_le_u32 vcc, s56, v61
    v_subrev_u32 v63, s56, v61
    v_add_u32 v55, s57, v180
    v_cndmask_b32 v61, v61, v63, vcc
    v_cndmask_b32 v180, v180, v55, vcc
    v_add_u32 v61, 64, v61
    v_add_u32 v181, 1024, v180
    v_cmp_le_u32 vcc, s56, v61
    v_subrev_u32 v63, s56, v61
    v_add_u32 v55, s57, v181
    v_cndmask_b32 v61, v61, v63, vcc
    v_cndmask_b32 v181, v181, v55, vcc
    v_add_u32 v61, 64, v61
    v_add_u32 v182, 1024, v181
    v_cmp_le_u32 vcc, s56, v61
    v_subrev_u32 v63, s56, v61
    v_add_u32 v55, s57, v182
    v_cndmask_b32 v61, v61, v63, vcc
    v_cndmask_b32 v182, v182, v55, vcc
    v_add_u32 v61, 64, v61
    v_add_u32 v183, 1024, v182
    v_cmp_le_u32 vcc, s56, v61
    v_subrev_u32 v63, s56, v61
    v_add_u32 v55, s57, v183
    v_cndmask_b32 v61, v61, v63, vcc
    v_cndmask_b32 v183, v183, v55, vcc
    v_add_u32 v61, 64, v61
    v_add_u32 v184, 1024, v183
    v_cmp_le_u32 vcc, s56, v61
    v_subrev_u32 v63, s56, v61
    v_add_u32 v55, s57, v184
    v_cndmask_b32 v61, v61, v63, vcc
    v_cndmask_b32 v184, v184, v55, vcc
    v_add_u32 v61, 64, v61
    v_add_u32 v185, 1024, v184
    v_cmp_le_u32 vcc, s56, v61
    v_subrev_u32 v63, s56, v61
    v_add_u32 v55, s57, v185
    v_cndmask_b32 v61, v61, v63, vcc
    v_cndmask_b32 v185, v185, v55, vcc
    s_waitcnt lgkmcnt(0)
    s_mov_b32 s4, s88
    s_mov_b32 s5, s89
    s_mov_b32 s6, 15630336
    s_mov_b32 s7, 0x20000
    v_mov_b32 v2, 0
    s_mov_b32 s14, 15396864
    buffer_load_dword v254, v2, s[4:7], s14 offen sc1
    s_and_b32 s12, s2, 7
    s_lshr_b32 s13, s2, 3
    s_mov_b32 s44, s64
    s_mov_b32 s45, s65
    s_mov_b32 s46, 2359296
    s_mov_b32 s47, 0x20000
    s_mov_b32 s48, s66
    s_mov_b32 s49, s67
    s_mov_b32 s50, 1990656
    s_mov_b32 s51, 0x20000
    s_mul_i32 s15, s13, 59
    v_add_u32 v2, s15, v1
    s_lshr_b32 s14, s12, 1
    s_lshl_b32 s14, s14, 9
    v_add_u32 v3, s14, v2
    v_mul_u32_u24 v174, 1152, v3
    v_subrev_u32 v3, 512, v2
    v_mul_u32_u24 v4, 4682, v3
    v_lshrrev_b32 v4, 16, v4
    v_mul_u32_u24 v5, 14, v4
    v_sub_u32 v5, v3, v5
    v_mul_u32_u24 v4, 3456, v4
    v_lshl_add_u32 v4, v5, 7, v4
    s_and_b32 s15, s12, 1
    s_mul_i32 s15, s15, 1664
    v_add_u32 v175, s15, v4
    v_mov_b32 v6, 0x7f000000
    v_cmp_gt_u32 vcc, 512, v2
    v_cmp_gt_u32 s[40:41], 59, v1
    s_movk_i32 s16, 1408
    v_cmp_gt_u32 s[42:43], s16, v2
    s_and_b64 s[40:41], s[40:41], s[42:43]
    s_and_b64 s[42:43], s[40:41], vcc
    s_andn2_b64 s[40:41], s[40:41], vcc
    v_cndmask_b32 v174, v6, v174, s[42:43]
    v_cndmask_b32 v175, v6, v175, s[40:41]
    s_lshl_b32 s14, s10, 7
    s_mul_i32 s15, s10, 221184
    buffer_load_dword v172, v174, s[44:47], s14 offen
    buffer_load_dword v173, v175, s[48:51], s15 offen
    s_waitcnt vmcnt(0)
    s_barrier
    s_mov_b32 s52, 0
    s_mov_b32 s53, 69632
    s_cmp_eq_u32 s11, 2
    s_cbranch_scc1 L_gemmV
    s_barrier
    v_add_u32 v12, 34816, v8
    v_add_u32 v13, 34816, v9
    v_add_u32 v14, 34816, v10
    v_add_u32 v15, 34816, v11
    ds_read_b128 v[32:35], v12
    ds_read_b128 v[36:39], v12 offset:2048
    ds_read_b64_tr_b16 v[136:137], v14 offset:0
    ds_read_b64_tr_b16 v[138:139], v14 offset:2304
    ds_read_b64_tr_b16 v[140:141], v14 offset:40
    ds_read_b64_tr_b16 v[142:143], v14 offset:2344
    ds_read_b64_tr_b16 v[144:145], v14 offset:72
    ds_read_b64_tr_b16 v[146:147], v14 offset:2376
    ds_read_b64_tr_b16 v[148:149], v14 offset:112
    ds_read_b64_tr_b16 v[150:151], v14 offset:2416
    ds_read_b64_tr_b16 v[152:153], v14 offset:144
    ds_read_b64_tr_b16 v[154:155], v14 offset:2448
L_cloopQ:
    ds_read_b64_tr_b16 v[156:157], v14 offset:184
    ds_read_b64_tr_b16 v[158:159], v14 offset:2488
    s_waitcnt lgkmcnt(10)
    v_mfma_f32_16x16x32_bf16 v[64:67], v[136:139], v[32:35], v[64:67]
    v_mfma_f32_16x16x32_bf16 v[68:71], v[136:139], v[36:39], v[68:71]
    ds_read_b64_tr_b16 v[136:137], v14 offset:216
    ds_read_b64_tr_b16 v[138:139], v14 offset:2520
    s_waitcnt lgkmcnt(10)
    v_mfma_f32_16x16x32_bf16 v[72:75], v[140:143], v[32:35], v[72:75]
    v_mfma_f32_16x16x32_bf16 v[76:79], v[140:143], v[36:39], v[76:79]
    ds_read_b128 v[40:43], v13
    ds_read_b128 v[44:47], v13 offset:2048
    ds_read_b64_tr_b16 v[140:141], v14 offset:256
    ds_read_b64_tr_b16 v[142:143], v14 offset:2560
    s_waitcnt lgkmcnt(12)
    v_mfma_f32_16x16x32_bf16 v[80:83], v[144:147], v[32:35], v[80:83]
    v_mfma_f32_16x16x32_bf16 v[84:87], v[144:147], v[36:39], v[84:87]
    ds_read_b64_tr_b16 v[144:145], v15 offset:0
    ds_read_b64_tr_b16 v[146:147], v15 offset:2304
    s_waitcnt lgkmcnt(12)
    v_mfma_f32_16x16x32_bf16 v[88:91], v[148:151], v[32:35], v[88:91]
    v_mfma_f32_16x16x32_bf16 v[92:95], v[148:151], v[36:39], v[92:95]
    ds_read_b64_tr_b16 v[148:149], v14 offset:9216
    ds_read_b64_tr_b16 v[150:151], v14 offset:11520
    s_waitcnt lgkmcnt(12)
    v_mfma_f32_16x16x32_bf16 v[96:99], v[152:155], v[32:35], v[96:99]
    v_mfma_f32_16x16x32_bf16 v[100:103], v[152:155], v[36:39], v[100:103]
    ds_read_b64_tr_b16 v[152:153], v14 offset:9256
    ds_read_b64_tr_b16 v[154:155], v14 offset:11560
    s_waitcnt lgkmcnt(12)
    v_mfma_f32_16x16x32_bf16 v[104:107], v[156:159], v[32:35], v[104:107]
    v_mfma_f32_16x16x32_bf16 v[108:111], v[156:159], v[36:39], v[108:111]
    ds_read_b64_tr_b16 v[156:157], v14 offset:9288
    ds_read_b64_tr_b16 v[158:159], v14 offset:11592
    s_waitcnt lgkmcnt(12)
    v_mfma_f32_16x16x32_bf16 v[112:115], v[136:139], v[32:35], v[112:115]
    v_mfma_f32_16x16x32_bf16 v[116:119], v[136:139], v[36:39], v[116:119]
    ds_read_b64_tr_b16 v[136:137], v14 offset:9328
    ds_read_b64_tr_b16 v[138:139], v14 offset:11632
    s_waitcnt lgkmcnt(10)
    v_mfma_f32_16x16x32_bf16 v[120:123], v[140:143], v[32:35], v[120:123]
    v_mfma_f32_16x16x32_bf16 v[124:127], v[140:143], v[36:39], v[124:127]
    ds_read_b64_tr_b16 v[140:141], v14 offset:9360
    ds_read_b64_tr_b16 v[142:143], v14 offset:11664
    s_waitcnt lgkmcnt(10)
    v_mfma_f32_16x16x32_bf16 v[128:131], v[144:147], v[32:35], v[128:131]
    v_mfma_f32_16x16x32_bf16 v[132:135], v[144:147], v[36:39], v[132:135]
    ds_read_b64_tr_b16 v[144:145], v14 offset:9400
    ds_read_b64_tr_b16 v[146:147], v14 offset:11704
    s_waitcnt lgkmcnt(10)
    v_mfma_f32_16x16x32_bf16 v[64:67], v[148:151], v[40:43], v[64:67]
    v_mfma_f32_16x16x32_bf16 v[68:71], v[148:151], v[44:47], v[68:71]
    ds_read_b64_tr_b16 v[148:149], v14 offset:9432
    ds_read_b64_tr_b16 v[150:151], v14 offset:11736
    s_waitcnt lgkmcnt(10)
    v_mfma_f32_16x16x32_bf16 v[72:75], v[152:155], v[40:43], v[72:75]
    v_mfma_f32_16x16x32_bf16 v[76:79], v[152:155], v[44:47], v[76:79]
    ds_read_b64_tr_b16 v[152:153], v14 offset:9472
    ds_read_b64_tr_b16 v[154:155], v14 offset:11776
    s_waitcnt lgkmcnt(10)
    v_mfma_f32_16x16x32_bf16 v[80:83], v[156:159], v[40:43], v[80:83]
    v_mfma_f32_16x16x32_bf16 v[84:87], v[156:159], v[44:47], v[84:87]
    ds_read_b64_tr_b16 v[156:157], v15 offset:9216
    ds_read_b64_tr_b16 v[158:159], v15 offset:11520
    s_waitcnt lgkmcnt(10)
    v_mfma_f32_16x16x32_bf16 v[88:91], v[136:139], v[40:43], v[88:91]
    v_mfma_f32_16x16x32_bf16 v[92:95], v[136:139], v[44:47], v[92:95]
    s_cmp_lt_u32 s52, 8
    s_cbranch_scc0 L_nobQ
    s_barrier
L_nobQ:
    v_add_u32 v160, s53, v8
    v_add_u32 v161, s53, v9
    v_add_u32 v162, s53, v10
    v_add_u32 v163, s53, v11
    ds_read_b64_tr_b16 v[136:137], v162 offset:0
    ds_read_b64_tr_b16 v[138:139], v162 offset:2304
    s_waitcnt lgkmcnt(10)
    v_mfma_f32_16x16x32_bf16 v[96:99], v[140:143], v[40:43], v[96:99]
    v_mfma_f32_16x16x32_bf16 v[100:103], v[140:143], v[44:47], v[100:103]
    ds_read_b64_tr_b16 v[140:141], v162 offset:40
    ds_read_b64_tr_b16 v[142:143], v162 offset:2344
    ds_read_b128 v[32:35], v160
    ds_read_b128 v[36:39], v160 offset:2048
    s_waitcnt lgkmcnt(12)
    v_mfma_f32_16x16x32_bf16 v[104:107], v[144:147], v[40:43], v[104:107]
    v_mfma_f32_16x16x32_bf16 v[108:111], v[144:147], v[44:47], v[108:111]
    ds_read_b64_tr_b16 v[144:145], v162 offset:72
    ds_read_b64_tr_b16 v[146:147], v162 offset:2376
    s_waitcnt lgkmcnt(12)
    v_mfma_f32_16x16x32_bf16 v[112:115], v[148:151], v[40:43], v[112:115]
    v_mfma_f32_16x16x32_bf16 v[116:119], v[148:151], v[44:47], v[116:119]
    ds_read_b64_tr_b16 v[148:149], v162 offset:112
    ds_read_b64_tr_b16 v[150:151], v162 offset:2416
    s_waitcnt lgkmcnt(12)
    v_mfma_f32_16x16x32_bf16 v[120:123], v[152:155], v[40:43], v[120:123]
    v_mfma_f32_16x16x32_bf16 v[124:127], v[152:155], v[44:47], v[124:127]
    ds_read_b64_tr_b16 v[152:153], v162 offset:144
    ds_read_b64_tr_b16 v[154:155], v162 offset:2448
    s_waitcnt lgkmcnt(12)
    v_mfma_f32_16x16x32_bf16 v[128:131], v[156:159], v[40:43], v[128:131]
    v_mfma_f32_16x16x32_bf16 v[132:135], v[156:159], v[44:47], v[132:135]
    v_mov_b32 v12, v160
    v_mov_b32 v13, v161
    v_mov_b32 v14, v162
    v_mov_b32 v15, v163
    s_add_u32 s53, s53, 34816
    s_cmp_eq_u32 s53, 139264
    s_cselect_b32 s53, 0, s53
    s_cmp_eq_u32 s52, 2
    s_cbranch_scc0 L_nopfQ
    s_cmp_eq_u32 s10, 1
    s_cbranch_scc0 L_nopfQ
    s_mov_b32 s24, s78
    s_mov_b32 s25, s79
    s_mov_b32 s26, 2359296
    s_mov_b32 s27, 0x20000
    v_lshlrev_b32 v2, 7, v1
    s_lshl_b32 s14, s34, 12
    buffer_load_dword v171, v2, s[24:27], s14 offen
L_nopfQ:
    s_cmp_eq_u32 s52, 0
    s_cbranch_scc0 L_nopfaQ
    s_add_u32 s16, s10, 4
    s_lshl_b32 s14, s16, 7
    s_mul_i32 s15, s16, 221184
    buffer_load_dword v172, v174, s[44:47], s14 offen
    buffer_load_dword v173, v175, s[48:51], s15 offen
    s_cmp_eq_u32 s10, 0
    s_cbranch_scc0 L_nopfaQ
    s_mov_b32 s16, 8
    s_lshl_b32 s14, s16, 7
    s_mul_i32 s15, s16, 221184
    buffer_load_dword v172, v174, s[44:47], s14 offen
    buffer_load_dword v173, v175, s[48:51], s15 offen
L_nopfaQ:
    s_add_u32 s52, s52, 1
    s_cmp_lt_u32 s52, 9
    s_cbranch_scc1 L_cloopQ
    s_waitcnt lgkmcnt(0)
    s_branch L_cdone_loop
L_gemmV:
    s_barrier
    v_add_u32 v12, 34816, v8
    v_add_u32 v13, 34816, v9
    v_add_u32 v14, 34816, v10
    v_add_u32 v15, 34816, v11
    ds_read_b128 v[32:35], v12
    ds_read_b128 v[36:39], v12 offset:2048
    ds_read_b64_tr_b16 v[136:137], v14 offset:0
    ds_read_b64_tr_b16 v[138:139], v14 offset:2304
    ds_read_b64_tr_b16 v[140:141], v14 offset:40
    ds_read_b64_tr_b16 v[142:143], v14 offset:2344
    ds_read_b64_tr_b16 v[144:145], v14 offset:72
    ds_read_b64_tr_b16 v[146:147], v14 offset:2376
    ds_read_b64_tr_b16 v[148:149], v14 offset:112
    ds_read_b64_tr_b16 v[150:151], v14 offset:2416
    ds_read_b64_tr_b16 v[152:153], v14 offset:144
    ds_read_b64_tr_b16 v[154:155], v14 offset:2448
L_cloopV:
    ds_read_b64_tr_b16 v[156:157], v14 offset:184
    ds_read_b64_tr_b16 v[158:159], v14 offset:2488
    s_waitcnt lgkmcnt(10)
    v_mfma_f32_16x16x32_bf16 v[64:67], v[32:35], v[136:139], v[64:67]
    v_mfma_f32_16x16x32_bf16 v[68:71], v[36:39], v[136:139], v[68:71]
    ds_read_b64_tr_b16 v[136:137], v14 offset:216
    ds_read_b64_tr_b16 v[138:139], v14 offset:2520
    s_waitcnt lgkmcnt(10)
    v_mfma_f32_16x16x32_bf16 v[72:75], v[32:35], v[140:143], v[72:75]
    v_mfma_f32_16x16x32_bf16 v[76:79], v[36:39], v[140:143], v[76:79]
    ds_read_b128 v[40:43], v13
    ds_read_b128 v[44:47], v13 offset:2048
    ds_read_b64_tr_b16 v[140:141], v14 offset:256
    ds_read_b64_tr_b16 v[142:143], v14 offset:2560
    s_waitcnt lgkmcnt(12)
    v_mfma_f32_16x16x32_bf16 v[80:83], v[32:35], v[144:147], v[80:83]
    v_mfma_f32_16x16x32_bf16 v[84:87], v[36:39], v[144:147], v[84:87]
    ds_read_b64_tr_b16 v[144:145], v15 offset:0
    ds_read_b64_tr_b16 v[146:147], v15 offset:2304
    s_waitcnt lgkmcnt(12)
    v_mfma_f32_16x16x32_bf16 v[88:91], v[32:35], v[148:151], v[88:91]
    v_mfma_f32_16x16x32_bf16 v[92:95], v[36:39], v[148:151], v[92:95]
    ds_read_b64_tr_b16 v[148:149], v14 offset:9216
    ds_read_b64_tr_b16 v[150:151], v14 offset:11520
    s_waitcnt lgkmcnt(12)
    v_mfma_f32_16x16x32_bf16 v[96:99], v[32:35], v[152:155], v[96:99]
    v_mfma_f32_16x16x32_bf16 v[100:103], v[36:39], v[152:155], v[100:103]
    ds_read_b64_tr_b16 v[152:153], v14 offset:9256
    ds_read_b64_tr_b16 v[154:155], v14 offset:11560
    s_waitcnt lgkmcnt(12)
    v_mfma_f32_16x16x32_bf16 v[104:107], v[32:35], v[156:159], v[104:107]
    v_mfma_f32_16x16x32_bf16 v[108:111], v[36:39], v[156:159], v[108:111]
    ds_read_b64_tr_b16 v[156:157], v14 offset:9288
    ds_read_b64_tr_b16 v[158:159], v14 offset:11592
    s_waitcnt lgkmcnt(12)
    v_mfma_f32_16x16x32_bf16 v[112:115], v[32:35], v[136:139], v[112:115]
    v_mfma_f32_16x16x32_bf16 v[116:119], v[36:39], v[136:139], v[116:119]
    ds_read_b64_tr_b16 v[136:137], v14 offset:9328
    ds_read_b64_tr_b16 v[138:139], v14 offset:11632
    s_waitcnt lgkmcnt(10)
    v_mfma_f32_16x16x32_bf16 v[120:123], v[32:35], v[140:143], v[120:123]
    v_mfma_f32_16x16x32_bf16 v[124:127], v[36:39], v[140:143], v[124:127]
    ds_read_b64_tr_b16 v[140:141], v14 offset:9360
    ds_read_b64_tr_b16 v[142:143], v14 offset:11664
    s_waitcnt lgkmcnt(10)
    v_mfma_f32_16x16x32_bf16 v[128:131], v[32:35], v[144:147], v[128:131]
    v_mfma_f32_16x16x32_bf16 v[132:135], v[36:39], v[144:147], v[132:135]
    ds_read_b64_tr_b16 v[144:145], v14 offset:9400
    ds_read_b64_tr_b16 v[146:147], v14 offset:11704
    s_waitcnt lgkmcnt(10)
    v_mfma_f32_16x16x32_bf16 v[64:67], v[40:43], v[148:151], v[64:67]
    v_mfma_f32_16x16x32_bf16 v[68:71], v[44:47], v[148:151], v[68:71]
    ds_read_b64_tr_b16 v[148:149], v14 offset:9432
    ds_read_b64_tr_b16 v[150:151], v14 offset:11736
    s_waitcnt lgkmcnt(10)
    v_mfma_f32_16x16x32_bf16 v[72:75], v[40:43], v[152:155], v[72:75]
    v_mfma_f32_16x16x32_bf16 v[76:79], v[44:47], v[152:155], v[76:79]
    ds_read_b64_tr_b16 v[152:153], v14 offset:9472
    ds_read_b64_tr_b16 v[154:155], v14 offset:11776
    s_waitcnt lgkmcnt(10)
    v_mfma_f32_16x16x32_bf16 v[80:83], v[40:43], v[156:159], v[80:83]
    v_mfma_f32_16x16x32_bf16 v[84:87], v[44:47], v[156:159], v[84:87]
    ds_read_b64_tr_b16 v[156:157], v15 offset:9216
    ds_read_b64_tr_b16 v[158:159], v15 offset:11520
    s_waitcnt lgkmcnt(10)
    v_mfma_f32_16x16x32_bf16 v[88:91], v[40:43], v[136:139], v[88:91]
    v_mfma_f32_16x16x32_bf16 v[92:95], v[44:47], v[136:139], v[92:95]
    s_cmp_lt_u32 s52, 8
    s_cbranch_scc0 L_nobV
    s_barrier
L_nobV:
    v_add_u32 v160, s53, v8
    v_add_u32 v161, s53, v9
    v_add_u32 v162, s53, v10
    v_add_u32 v163, s53, v11
    ds_read_b64_tr_b16 v[136:137], v162 offset:0
    ds_read_b64_tr_b16 v[138:139], v162 offset:2304
    s_waitcnt lgkmcnt(10)
    v_mfma_f32_16x16x32_bf16 v[96:99], v[40:43], v[140:143], v[96:99]
    v_mfma_f32_16x16x32_bf16 v[100:103], v[44:47], v[140:143], v[100:103]
    ds_read_b64_tr_b16 v[140:141], v162 offset:40
    ds_read_b64_tr_b16 v[142:143], v162 offset:2344
    ds_read_b128 v[32:35], v160
    ds_read_b128 v[36:39], v160 offset:2048
    s_waitcnt lgkmcnt(12)
    v_mfma_f32_16x16x32_bf16 v[104:107], v[40:43], v[144:147], v[104:107]
    v_mfma_f32_16x16x32_bf16 v[108:111], v[44:47], v[144:147], v[108:111]
    ds_read_b64_tr_b16 v[144:145], v162 offset:72
    ds_read_b64_tr_b16 v[146:147], v162 offset:2376
    s_waitcnt lgkmcnt(12)
    v_mfma_f32_16x16x32_bf16 v[112:115], v[40:43], v[148:151], v[112:115]
    v_mfma_f32_16x16x32_bf16 v[116:119], v[44:47], v[148:151], v[116:119]
    ds_read_b64_tr_b16 v[148:149], v162 offset:112
    ds_read_b64_tr_b16 v[150:151], v162 offset:2416
    s_waitcnt lgkmcnt(12)
    v_mfma_f32_16x16x32_bf16 v[120:123], v[40:43], v[152:155], v[120:123]
    v_mfma_f32_16x16x32_bf16 v[124:127], v[44:47], v[152:155], v[124:127]
    ds_read_b64_tr_b16 v[152:153], v162 offset:144
    ds_read_b64_tr_b16 v[154:155], v162 offset:2448
    s_waitcnt lgkmcnt(12)
    v_mfma_f32_16x16x32_bf16 v[128:131], v[40:43], v[156:159], v[128:131]
    v_mfma_f32_16x16x32_bf16 v[132:135], v[44:47], v[156:159], v[132:135]
    v_mov_b32 v12, v160
    v_mov_b32 v13, v161
    v_mov_b32 v14, v162
    v_mov_b32 v15, v163
    s_add_u32 s53, s53, 34816
    s_cmp_eq_u32 s53, 139264
    s_cselect_b32 s53, 0, s53
    s_cmp_eq_u32 s52, 2
    s_cbranch_scc0 L_nopfV
    s_cmp_eq_u32 s10, 1
    s_cbranch_scc0 L_nopfV
    s_mov_b32 s24, s78
    s_mov_b32 s25, s79
    s_mov_b32 s26, 2359296
    s_mov_b32 s27, 0x20000
    v_lshlrev_b32 v2, 7, v1
    s_lshl_b32 s14, s34, 12
    buffer_load_dword v171, v2, s[24:27], s14 offen
L_nopfV:
    s_cmp_eq_u32 s52, 0
    s_cbranch_scc0 L_nopfaV
    s_add_u32 s16, s10, 4
    s_lshl_b32 s14, s16, 7
    s_mul_i32 s15, s16, 221184
    buffer_load_dword v172, v174, s[44:47], s14 offen
    buffer_load_dword v173, v175, s[48:51], s15 offen
    s_cmp_eq_u32 s10, 0
    s_cbranch_scc0 L_nopfaV
    s_mov_b32 s16, 8
    s_lshl_b32 s14, s16, 7
    s_mul_i32 s15, s16, 221184
    buffer_load_dword v172, v174, s[44:47], s14 offen
    buffer_load_dword v173, v175, s[48:51], s15 offen
L_nopfaV:
    s_add_u32 s52, s52, 1
    s_cmp_lt_u32 s52, 9
    s_cbranch_scc1 L_cloopV
    s_waitcnt lgkmcnt(0)
L_cdone_loop:
    s_waitcnt vmcnt(0)
    v_readfirstlane_b32 s3, v254
    s_mul_i32 s3, s3, 0x0019660d
    s_add_u32 s3, s3, 0x3c6ef35f
    s_nop 7
    v_and_b32 v2, 15, v1
    v_lshrrev_b32 v3, 4, v1
    s_lshl_b32 s14, s8, 2
    s_add_u32 s14, s14, s10
    s_lshl_b32 s15, s9, 3
    v_and_b32 v5, 1, v3
    s_mul_i32 s59, s10, 10240
    s_add_u32 s59, s59, 69632
    s_cmp_eq_u32 s11, 2
    s_cbranch_scc1 L_epV
    v_lshrrev_b32 v4, 1, v3
    v_lshlrev_b32 v4, 9, v4
    v_lshl_add_u32 v4, v2, 4, v4
    v_lshl_add_u32 v4, v5, 3, v4
    v_add_u32 v4, s59, v4
    s_mov_b32 s58, 1051597459
    s_cmp_eq_u32 s11, 0
    s_cselect_b32 s58, s58, 1.0
    v_pk_mul_f32 v[64:65], v[64:65], s[58:59] op_sel_hi:[1,0]
    v_pk_mul_f32 v[66:67], v[66:67], s[58:59] op_sel_hi:[1,0]
    v_cvt_pk_bf16_f32 v16, v64, v65
    v_cvt_pk_bf16_f32 v17, v66, v67
    ds_write_b64 v4, v[16:17] offset:0
    v_pk_mul_f32 v[68:69], v[68:69], s[58:59] op_sel_hi:[1,0]
    v_pk_mul_f32 v[70:71], v[70:71], s[58:59] op_sel_hi:[1,0]
    v_cvt_pk_bf16_f32 v18, v68, v69
    v_cvt_pk_bf16_f32 v19, v70, v71
    ds_write_b64 v4, v[18:19] offset:256
    v_pk_mul_f32 v[72:73], v[72:73], s[58:59] op_sel_hi:[1,0]
    v_pk_mul_f32 v[74:75], v[74:75], s[58:59] op_sel_hi:[1,0]
    v_cvt_pk_bf16_f32 v20, v72, v73
    v_cvt_pk_bf16_f32 v21, v74, v75
    ds_write_b64 v4, v[20:21] offset:1152
    v_pk_mul_f32 v[76:77], v[76:77], s[58:59] op_sel_hi:[1,0]
    v_pk_mul_f32 v[78:79], v[78:79], s[58:59] op_sel_hi:[1,0]
    v_cvt_pk_bf16_f32 v22, v76, v77
    v_cvt_pk_bf16_f32 v23, v78, v79
    ds_write_b64 v4, v[22:23] offset:1408
    v_pk_mul_f32 v[80:81], v[80:81], s[58:59] op_sel_hi:[1,0]
    v_pk_mul_f32 v[82:83], v[82:83], s[58:59] op_sel_hi:[1,0]
    v_cvt_pk_bf16_f32 v24, v80, v81
    v_cvt_pk_bf16_f32 v25, v82, v83
    ds_write_b64 v4, v[24:25] offset:2304
    v_pk_mul_f32 v[84:85], v[84:85], s[58:59] op_sel_hi:[1,0]
    v_pk_mul_f32 v[86:87], v[86:87], s[58:59] op_sel_hi:[1,0]
    v_cvt_pk_bf16_f32 v26, v84, v85
    v_cvt_pk_bf16_f32 v27, v86, v87
    ds_write_b64 v4, v[26:27] offset:2560
    v_pk_mul_f32 v[88:89], v[88:89], s[58:59] op_sel_hi:[1,0]
    v_pk_mul_f32 v[90:91], v[90:91], s[58:59] op_sel_hi:[1,0]
    v_cvt_pk_bf16_f32 v28, v88, v89
    v_cvt_pk_bf16_f32 v29, v90, v91
    ds_write_b64 v4, v[28:29] offset:3456
    v_pk_mul_f32 v[92:93], v[92:93], s[58:59] op_sel_hi:[1,0]
    v_pk_mul_f32 v[94:95], v[94:95], s[58:59] op_sel_hi:[1,0]
    v_cvt_pk_bf16_f32 v30, v92, v93
    v_cvt_pk_bf16_f32 v31, v94, v95
    ds_write_b64 v4, v[30:31] offset:3712
    v_pk_mul_f32 v[96:97], v[96:97], s[58:59] op_sel_hi:[1,0]
    v_pk_mul_f32 v[98:99], v[98:99], s[58:59] op_sel_hi:[1,0]
    v_cvt_pk_bf16_f32 v32, v96, v97
    v_cvt_pk_bf16_f32 v33, v98, v99
    ds_write_b64 v4, v[32:33] offset:4608
    v_pk_mul_f32 v[100:101], v[100:101], s[58:59] op_sel_hi:[1,0]
    v_pk_mul_f32 v[102:103], v[102:103], s[58:59] op_sel_hi:[1,0]
    v_cvt_pk_bf16_f32 v34, v100, v101
    v_cvt_pk_bf16_f32 v35, v102, v103
    ds_write_b64 v4, v[34:35] offset:4864
    v_pk_mul_f32 v[104:105], v[104:105], s[58:59] op_sel_hi:[1,0]
    v_pk_mul_f32 v[106:107], v[106:107], s[58:59] op_sel_hi:[1,0]
    v_cvt_pk_bf16_f32 v36, v104, v105
    v_cvt_pk_bf16_f32 v37, v106, v107
    ds_write_b64 v4, v[36:37] offset:5760
    v_pk_mul_f32 v[108:109], v[108:109], s[58:59] op_sel_hi:[1,0]
    v_pk_mul_f32 v[110:111], v[110:111], s[58:59] op_sel_hi:[1,0]
    v_cvt_pk_bf16_f32 v38, v108, v109
    v_cvt_pk_bf16_f32 v39, v110, v111
    ds_write_b64 v4, v[38:39] offset:6016
    v_pk_mul_f32 v[112:113], v[112:113], s[58:59] op_sel_hi:[1,0]
    v_pk_mul_f32 v[114:115], v[114:115], s[58:59] op_sel_hi:[1,0]
    v_cvt_pk_bf16_f32 v40, v112, v113
    v_cvt_pk_bf16_f32 v41, v114, v115
    ds_write_b64 v4, v[40:41] offset:6912
    v_pk_mul_f32 v[116:117], v[116:117], s[58:59] op_sel_hi:[1,0]
    v_pk_mul_f32 v[118:119], v[118:119], s[58:59] op_sel_hi:[1,0]
    v_cvt_pk_bf16_f32 v42, v116, v117
    v_cvt_pk_bf16_f32 v43, v118, v119
    ds_write_b64 v4, v[42:43] offset:7168
    v_pk_mul_f32 v[120:121], v[120:121], s[58:59] op_sel_hi:[1,0]
    v_pk_mul_f32 v[122:123], v[122:123], s[58:59] op_sel_hi:[1,0]
    v_cvt_pk_bf16_f32 v44, v120, v121
    v_cvt_pk_bf16_f32 v45, v122, v123
    ds_write_b64 v4, v[44:45] offset:8064
    v_pk_mul_f32 v[124:125], v[124:125], s[58:59] op_sel_hi:[1,0]
    v_pk_mul_f32 v[126:127], v[126:127], s[58:59] op_sel_hi:[1,0]
    v_cvt_pk_bf16_f32 v46, v124, v125
    v_cvt_pk_bf16_f32 v47, v126, v127
    ds_write_b64 v4, v[46:47] offset:8320
    v_pk_mul_f32 v[128:129], v[128:129], s[58:59] op_sel_hi:[1,0]
    v_pk_mul_f32 v[130:131], v[130:131], s[58:59] op_sel_hi:[1,0]
    v_cvt_pk_bf16_f32 v48, v128, v129
    v_cvt_pk_bf16_f32 v49, v130, v131
    v_pk_mul_f32 v[132:133], v[132:133], s[58:59] op_sel_hi:[1,0]
    v_pk_mul_f32 v[134:135], v[134:135], s[58:59] op_sel_hi:[1,0]
    v_cvt_pk_bf16_f32 v50, v132, v133
    v_cvt_pk_bf16_f32 v51, v134, v135
    v_mul_u32_u24 v6, 2304, v3
    v_lshl_add_u32 v6, v2, 2, v6
    v_add_u32 v6, s59, v6
    ds_write_b32 v6, v48 offset:1024
    ds_write_b32 v6, v49 offset:2176
    ds_write_b32 v6, v50 offset:1088
    ds_write_b32 v6, v51 offset:2240
    s_mul_i32 s54, s15, 155648
    s_mul_i32 s56, s14, 2432
    s_add_u32 s54, s54, s56
    s_mul_i32 s56, s15, 73728
    s_mul_i32 s57, s14, 1152
    s_add_u32 s56, s56, s57
    s_add_u32 s56, s56, 5242880
    s_mov_b32 s57, 155648
    s_cmp_eq_u32 s11, 0
    s_cselect_b32 s54, s56, s54
    s_cselect_b32 s55, 73728, s57
    v_lshlrev_b32 v60, 4, v1
    v_add_u32 v60, s59, v60
    s_waitcnt lgkmcnt(0)
    ds_read_b128 v[96:99], v60 offset:0
    ds_read_b128 v[100:103], v60 offset:1024
    ds_read_b128 v[104:107], v60 offset:2048
    ds_read_b128 v[108:111], v60 offset:3072
    ds_read_b128 v[112:115], v60 offset:4096
    ds_read_b128 v[116:119], v60 offset:5120
    ds_read_b128 v[120:123], v60 offset:6144
    ds_read_b128 v[124:127], v60 offset:7168
    ds_read_b128 v[128:131], v60 offset:8192
    s_waitcnt lgkmcnt(8)
    buffer_store_dwordx4 v[96:99], v176, s[4:7], s54 offen sc1
    s_waitcnt lgkmcnt(7)
    buffer_store_dwordx4 v[100:103], v177, s[4:7], s54 offen sc1
    s_waitcnt lgkmcnt(6)
    buffer_store_dwordx4 v[104:107], v178, s[4:7], s54 offen sc1
    s_waitcnt lgkmcnt(5)
    buffer_store_dwordx4 v[108:111], v179, s[4:7], s54 offen sc1
    s_waitcnt lgkmcnt(4)
    buffer_store_dwordx4 v[112:115], v180, s[4:7], s54 offen sc1
    s_waitcnt lgkmcnt(3)
    buffer_store_dwordx4 v[116:119], v181, s[4:7], s54 offen sc1
    s_waitcnt lgkmcnt(2)
    buffer_store_dwordx4 v[120:123], v182, s[4:7], s54 offen sc1
    s_waitcnt lgkmcnt(1)
    buffer_store_dwordx4 v[124:127], v183, s[4:7], s54 offen sc1
    s_waitcnt lgkmcnt(0)
    buffer_store_dwordx4 v[128:131], v184, s[4:7], s54 offen sc1
    s_branch L_epdone
L_epV:
    v_lshrrev_b32 v6, 1, v3
    v_mul_u32_u24 v6, 320, v6
    v_lshl_add_u32 v6, v5, 3, v6
    v_add_u32 v6, s59, v6
    v_lshl_add_u32 v4, v2, 4, v6
    v_cvt_pk_bf16_f32 v16, v64, v65
    v_cvt_pk_bf16_f32 v17, v66, v67
    ds_write_b64 v4, v[16:17] offset:0
    v_cvt_pk_bf16_f32 v18, v68, v69
    v_cvt_pk_bf16_f32 v19, v70, v71
    ds_write_b64 v4, v[18:19] offset:640
    v_cvt_pk_bf16_f32 v20, v72, v73
    v_cvt_pk_bf16_f32 v21, v74, v75
    ds_write_b64 v4, v[20:21] offset:1280
    v_cvt_pk_bf16_f32 v22, v76, v77
    v_cvt_pk_bf16_f32 v23, v78, v79
    ds_write_b64 v4, v[22:23] offset:1920
    v_cvt_pk_bf16_f32 v24, v80, v81
    v_cvt_pk_bf16_f32 v25, v82, v83
    ds_write_b64 v4, v[24:25] offset:2560
    v_cvt_pk_bf16_f32 v26, v84, v85
    v_cvt_pk_bf16_f32 v27, v86, v87
    ds_write_b64 v4, v[26:27] offset:3200
    v_cvt_pk_bf16_f32 v28, v88, v89
    v_cvt_pk_bf16_f32 v29, v90, v91
    ds_write_b64 v4, v[28:29] offset:3840
    v_cvt_pk_bf16_f32 v30, v92, v93
    v_cvt_pk_bf16_f32 v31, v94, v95
    ds_write_b64 v4, v[30:31] offset:4480
    v_cvt_pk_bf16_f32 v32, v96, v97
    v_cvt_pk_bf16_f32 v33, v98, v99
    ds_write_b64 v4, v[32:33] offset:5120
    v_cvt_pk_bf16_f32 v34, v100, v101
    v_cvt_pk_bf16_f32 v35, v102, v103
    ds_write_b64 v4, v[34:35] offset:5760
    v_cvt_pk_bf16_f32 v36, v104, v105
    v_cvt_pk_bf16_f32 v37, v106, v107
    ds_write_b64 v4, v[36:37] offset:6400
    v_cvt_pk_bf16_f32 v38, v108, v109
    v_cvt_pk_bf16_f32 v39, v110, v111
    ds_write_b64 v4, v[38:39] offset:7040
    v_cvt_pk_bf16_f32 v40, v112, v113
    v_cvt_pk_bf16_f32 v41, v114, v115
    ds_write_b64 v4, v[40:41] offset:7680
    v_cvt_pk_bf16_f32 v42, v116, v117
    v_cvt_pk_bf16_f32 v43, v118, v119
    ds_write_b64 v4, v[42:43] offset:8320
    v_cvt_pk_bf16_f32 v44, v120, v121
    v_cvt_pk_bf16_f32 v45, v122, v123
    ds_write_b64 v4, v[44:45] offset:8960
    v_cvt_pk_bf16_f32 v46, v124, v125
    v_cvt_pk_bf16_f32 v47, v126, v127
    ds_write_b64 v4, v[46:47] offset:9600
    v_cvt_pk_bf16_f32 v48, v128, v129
    v_cvt_pk_bf16_f32 v49, v130, v131
    v_cvt_pk_bf16_f32 v50, v132, v133
    v_cvt_pk_bf16_f32 v51, v134, v135
    v_lshrrev_b32 v7, 1, v2
    v_mul_u32_u24 v7, 1280, v7
    v_and_b32 v5, 1, v2
    v_lshl_add_u32 v7, v5, 4, v7
    v_add_u32 v7, v7, v6
    ds_write_b64 v7, v[48:49] offset:256
    ds_write_b64 v7, v[50:51] offset:896
    v_lshrrev_b32 v7, 3, v1
    v_mul_u32_u24 v7, 1280, v7
    v_bfe_u32 v5, v1, 1, 2
    v_mul_u32_u24 v5, 320, v5
    v_add_u32 v7, v7, v5
    v_and_b32 v5, 1, v1
    v_lshl_add_u32 v7, v5, 4, v7
    v_add_u32 v7, s59, v7
    v_cmp_eq_u32 vcc, 0, v5
    v_mov_b32 v6, 0x3f803f80
    s_nop 0
    v_cndmask_b32 v56, 0, v6, vcc
    v_mov_b32 v57, v56
    v_mov_b32 v58, v56
    v_mov_b32 v59, v56
    ds_write_b128 v7, v[56:59] offset:288
    s_mul_i32 s54, s15, 155648
    s_mul_i32 s56, s14, 2432
    s_add_u32 s54, s54, s56
    s_add_u32 s54, s54, 1152
    s_mov_b32 s55, 155648
    v_lshlrev_b32 v60, 4, v1
    v_add_u32 v60, s59, v60
    s_waitcnt lgkmcnt(0)
    ds_read_b128 v[96:99], v60 offset:0
    ds_read_b128 v[100:103], v60 offset:1024
    ds_read_b128 v[104:107], v60 offset:2048
    ds_read_b128 v[108:111], v60 offset:3072
    ds_read_b128 v[112:115], v60 offset:4096
    ds_read_b128 v[116:119], v60 offset:5120
    ds_read_b128 v[120:123], v60 offset:6144
    ds_read_b128 v[124:127], v60 offset:7168
    ds_read_b128 v[128:131], v60 offset:8192
    ds_read_b128 v[132:135], v60 offset:9216
    s_waitcnt lgkmcnt(9)
    buffer_store_dwordx4 v[96:99], v176, s[4:7], s54 offen sc1
    s_waitcnt lgkmcnt(8)
    buffer_store_dwordx4 v[100:103], v177, s[4:7], s54 offen sc1
    s_waitcnt lgkmcnt(7)
    buffer_store_dwordx4 v[104:107], v178, s[4:7], s54 offen sc1
    s_waitcnt lgkmcnt(6)
    buffer_store_dwordx4 v[108:111], v179, s[4:7], s54 offen sc1
    s_waitcnt lgkmcnt(5)
    buffer_store_dwordx4 v[112:115], v180, s[4:7], s54 offen sc1
    s_waitcnt lgkmcnt(4)
    buffer_store_dwordx4 v[116:119], v181, s[4:7], s54 offen sc1
    s_waitcnt lgkmcnt(3)
    buffer_store_dwordx4 v[120:123], v182, s[4:7], s54 offen sc1
    s_waitcnt lgkmcnt(2)
    buffer_store_dwordx4 v[124:127], v183, s[4:7], s54 offen sc1
    s_waitcnt lgkmcnt(1)
    buffer_store_dwordx4 v[128:131], v184, s[4:7], s54 offen sc1
    s_waitcnt lgkmcnt(0)
    buffer_store_dwordx4 v[132:135], v185, s[4:7], s54 offen sc1
L_epdone:
    s_branch L_afterA
L_aux:
    s_waitcnt lgkmcnt(0)
    s_mov_b32 s4, s88
    s_mov_b32 s5, s89
    s_mov_b32 s6, 15630336
    s_mov_b32 s7, 0x20000
    v_mov_b32 v2, 0
    s_mov_b32 s14, 15396864
    buffer_load_dword v254, v2, s[4:7], s14 offen sc1
    s_mov_b32 s24, s72
    s_mov_b32 s25, s73
    s_mov_b32 s26, 2359296
    s_mov_b32 s27, 0x20000
    s_mov_b32 s28, s74
    s_mov_b32 s29, s75
    s_mov_b32 s30, 2359296
    s_mov_b32 s31, 0x20000
    s_mov_b32 s44, s76
    s_mov_b32 s45, s77
    s_mov_b32 s46, 4608
    s_mov_b32 s47, 0x20000
    s_mov_b32 s48, s64
    s_mov_b32 s49, s65
    s_mov_b32 s50, 2359296
    s_mov_b32 s51, 0x20000
    s_mov_b32 s52, s82
    s_mov_b32 s53, s83
    s_mov_b32 s54, 1152
    s_mov_b32 s55, 0x20000
    v_lshlrev_b32 v2, 4, v1
    s_mul_i32 s36, s33, 36864
    s_lshl_b32 s37, s10, 10
    s_add_u32 s38, s36, s37
    s_sub_u32 s39, s38, 3456
    v_add_u32 v3, s39, v2
    s_add_u32 m0, s37, 0
    s_nop 0
    buffer_load_dwordx4 v3, s[24:27], 0 offen lds
    v_add_u32 v3, 8192, v3
    s_add_u32 m0, s37, 8192
    s_nop 0
    buffer_load_dwordx4 v3, s[24:27], 0 offen lds
    v_add_u32 v3, 8192, v3
    s_add_u32 m0, s37, 16384
    s_nop 0
    buffer_load_dwordx4 v3, s[24:27], 0 offen lds
    v_add_u32 v3, 8192, v3
    s_add_u32 m0, s37, 24576
    s_nop 0
    buffer_load_dwordx4 v3, s[24:27], 0 offen lds
    v_add_u32 v3, 8192, v3
    s_add_u32 m0, s37, 32768
    s_nop 0
    buffer_load_dwordx4 v3, s[24:27], 0 offen lds
    v_add_u32 v3, s38, v2
    s_add_u32 m0, s37, 40960
    s_nop 0
    buffer_load_dwordx4 v3, s[28:31], 0 offen lds
    v_add_u32 v3, 8192, v3
    s_add_u32 m0, s37, 49152
    s_nop 0
    buffer_load_dwordx4 v3, s[28:31], 0 offen lds
    v_add_u32 v3, 8192, v3
    s_add_u32 m0, s37, 57344
    s_nop 0
    buffer_load_dwordx4 v3, s[28:31], 0 offen lds
    v_add_u32 v3, 8192, v3
    s_add_u32 m0, s37, 65536
    s_nop 0
    buffer_load_dwordx4 v3, s[28:31], 0 offen lds
    v_add_u32 v3, 8192, v3
    s_cmp_lt_u32 s10, 4
    s_cbranch_scc0 L_axd
    s_add_u32 m0, s37, 73728
    s_nop 0
    buffer_load_dwordx4 v3, s[28:31], 0 offen lds
L_axd:
    v_lshrrev_b32 v3, 2, v1
    s_lshl_b32 s38, s10, 4
    v_add_u32 v3, s38, v3
    v_and_b32 v4, 3, v1
    v_lshlrev_b32 v6, 5, v3
    buffer_load_dwordx4 v[70:73], v6, s[44:47], 0 offen
    buffer_load_dwordx4 v[74:77], v6, s[44:47], 0 offen offset:16
    v_lshrrev_b32 v6, 2, v1
    v_lshlrev_b32 v6, 5, v6
    s_lshl_b32 s38, s10, 4
    s_add_u32 s38, s38, 4096
    buffer_load_dwordx4 v[78:81], v6, s[44:47], s38 offen
    v_mul_u32_u24 v5, 9216, v4
    v_lshl_add_u32 v5, v3, 3, v5
    v_sub_u32 v4, 3, v4
    v_lshlrev_b32 v4, 4, v4
    s_mul_i32 s38, s33, 36864
    s_add_u32 s38, s38, 7626752
    s_waitcnt vmcnt(0)
    v_readfirstlane_b32 s3, v254
    s_mul_i32 s3, s3, 0x0019660d
    s_add_u32 s3, s3, 0x3c6ef35f
    s_barrier
    ds_read_b64 v[32:33], v5 offset:0
    ds_read_b64 v[34:35], v5 offset:1152
    ds_read_b64 v[36:37], v5 offset:2304
    ds_read_b64 v[38:39], v5 offset:3456
    ds_read_b64 v[40:41], v5 offset:4608
    ds_read_b64 v[42:43], v5 offset:5760
    ds_read_b64 v[44:45], v5 offset:6912
    ds_read_b64 v[46:47], v5 offset:8064
    ds_read_b64 v[48:49], v5 offset:9216
    ds_read_b64 v[50:51], v5 offset:10368
    ds_read_b64 v[52:53], v5 offset:11520
    s_waitcnt lgkmcnt(4)
    ds_read_b64 v[54:55], v5 offset:40960
    ds_read_b64 v[56:57], v5 offset:42112
    ds_read_b64 v[58:59], v5 offset:43264
    ds_read_b64 v[60:61], v5 offset:44416
    ds_read_b64 v[62:63], v5 offset:45568
    ds_read_b64 v[64:65], v5 offset:46720
    ds_read_b64 v[66:67], v5 offset:47872
    ds_read_b64 v[68:69], v5 offset:49024
    v_mul_u32_u24 v2, 1821, v3
    v_lshrrev_b32 v2, 16, v2
    v_mul_u32_u24 v7, 36, v2
    v_sub_u32 v7, v3, v7
    v_mul_u32_u24 v2, 9216, v2
    v_lshl_add_u32 v7, v7, 8, v2
    v_add_u32 v7, v7, v4
    s_waitcnt lgkmcnt(0)
    s_mov_b32 s37, 0
L_prep_u:
    v_lshlrev_b32 v184, 16, v70
    v_lshlrev_b32 v185, 16, v72
    v_and_b32 v186, 0xffff0000, v70
    v_and_b32 v187, 0xffff0000, v72
    v_lshlrev_b32 v188, 16, v71
    v_lshlrev_b32 v189, 16, v73
    v_and_b32 v190, 0xffff0000, v71
    v_and_b32 v191, 0xffff0000, v73
    v_lshlrev_b32 v192, 16, v32
    v_and_b32 v193, 0xffff0000, v32
    v_lshlrev_b32 v194, 16, v34
    v_and_b32 v195, 0xffff0000, v34
    v_lshlrev_b32 v196, 16, v36
    v_and_b32 v197, 0xffff0000, v36
    v_lshlrev_b32 v198, 16, v38
    v_and_b32 v199, 0xffff0000, v38
    v_lshlrev_b32 v200, 16, v40
    v_and_b32 v201, 0xffff0000, v40
    v_lshlrev_b32 v202, 16, v42
    v_and_b32 v203, 0xffff0000, v42
    v_lshlrev_b32 v204, 16, v44
    v_and_b32 v205, 0xffff0000, v44
    v_lshlrev_b32 v206, 16, v46
    v_and_b32 v207, 0xffff0000, v46
    v_lshlrev_b32 v208, 16, v48
    v_and_b32 v209, 0xffff0000, v48
    v_lshlrev_b32 v210, 16, v50
    v_and_b32 v211, 0xffff0000, v50
    v_lshlrev_b32 v212, 16, v52
    v_and_b32 v213, 0xffff0000, v52
    v_pk_mul_f32 v[214:215], v[184:185], v[198:199]
    v_pk_fma_f32 v[214:215], v[186:187], v[196:197], v[214:215]
    v_pk_fma_f32 v[214:215], v[188:189], v[194:195], v[214:215]
    v_pk_fma_f32 v[214:215], v[190:191], v[192:193], v[214:215]
    v_pk_mul_f32 v[216:217], v[184:185], v[200:201]
    v_pk_fma_f32 v[216:217], v[186:187], v[198:199], v[216:217]
    v_pk_fma_f32 v[216:217], v[188:189], v[196:197], v[216:217]
    v_pk_fma_f32 v[216:217], v[190:191], v[194:195], v[216:217]
    v_pk_mul_f32 v[218:219], v[184:185], v[202:203]
    v_pk_fma_f32 v[218:219], v[186:187], v[200:201], v[218:219]
    v_pk_fma_f32 v[218:219], v[188:189], v[198:199], v[218:219]
    v_pk_fma_f32 v[218:219], v[190:191], v[196:197], v[218:219]
    v_pk_mul_f32 v[220:221], v[184:185], v[204:205]
    v_pk_fma_f32 v[220:221], v[186:187], v[202:203], v[220:221]
    v_pk_fma_f32 v[220:221], v[188:189], v[200:201], v[220:221]
    v_pk_fma_f32 v[220:221], v[190:191], v[198:199], v[220:221]
    v_pk_mul_f32 v[222:223], v[184:185], v[206:207]
    v_pk_fma_f32 v[222:223], v[186:187], v[204:205], v[222:223]
    v_pk_fma_f32 v[222:223], v[188:189], v[202:203], v[222:223]
    v_pk_fma_f32 v[222:223], v[190:191], v[200:201], v[222:223]
    v_pk_mul_f32 v[224:225], v[184:185], v[208:209]
    v_pk_fma_f32 v[224:225], v[186:187], v[206:207], v[224:225]
    v_pk_fma_f32 v[224:225], v[188:189], v[204:205], v[224:225]
    v_pk_fma_f32 v[224:225], v[190:191], v[202:203], v[224:225]
    v_pk_mul_f32 v[226:227], v[184:185], v[210:211]
    v_pk_fma_f32 v[226:227], v[186:187], v[208:209], v[226:227]
    v_pk_fma_f32 v[226:227], v[188:189], v[206:207], v[226:227]
    v_pk_fma_f32 v[226:227], v[190:191], v[204:205], v[226:227]
    v_pk_mul_f32 v[228:229], v[184:185], v[212:213]
    v_pk_fma_f32 v[228:229], v[186:187], v[210:211], v[228:229]
    v_pk_fma_f32 v[228:229], v[188:189], v[208:209], v[228:229]
    v_pk_fma_f32 v[228:229], v[190:191], v[206:207], v[228:229]
    v_lshlrev_b32 v192, 16, v54
    v_and_b32 v193, 0xffff0000, v54
    v_lshlrev_b32 v194, 16, v56
    v_and_b32 v195, 0xffff0000, v56
    v_lshlrev_b32 v196, 16, v58
    v_and_b32 v197, 0xffff0000, v58
    v_lshlrev_b32 v198, 16, v60
    v_and_b32 v199, 0xffff0000, v60
    v_lshlrev_b32 v200, 16, v62
    v_and_b32 v201, 0xffff0000, v62
    v_lshlrev_b32 v202, 16, v64
    v_and_b32 v203, 0xffff0000, v64
    v_lshlrev_b32 v204, 16, v66
    v_and_b32 v205, 0xffff0000, v66
    v_lshlrev_b32 v206, 16, v68
    v_and_b32 v207, 0xffff0000, v68
    v_pk_mul_f32 v[214:215], v[214:215], v[192:193]
    v_pk_mul_f32 v[216:217], v[216:217], v[194:195]
    v_pk_mul_f32 v[218:219], v[218:219], v[196:197]
    v_pk_mul_f32 v[220:221], v[220:221], v[198:199]
    v_pk_mul_f32 v[222:223], v[222:223], v[200:201]
    v_pk_mul_f32 v[224:225], v[224:225], v[202:203]
    v_pk_mul_f32 v[226:227], v[226:227], v[204:205]
    v_pk_mul_f32 v[228:229], v[228:229], v[206:207]
    v_cvt_pk_bf16_f32 v232, v228, v226
    v_cvt_pk_bf16_f32 v233, v224, v222
    v_cvt_pk_bf16_f32 v234, v220, v218
    v_cvt_pk_bf16_f32 v235, v216, v214
    buffer_store_dwordx4 v[232:235], v7, s[4:7], s38 offen offset:0 sc1
    v_cvt_pk_bf16_f32 v236, v229, v227
    v_cvt_pk_bf16_f32 v237, v225, v223
    v_cvt_pk_bf16_f32 v238, v221, v219
    v_cvt_pk_bf16_f32 v239, v217, v215
    buffer_store_dwordx4 v[236:239], v7, s[4:7], s38 offen offset:64 sc1
    s_cmp_eq_u32 s37, 0
    s_cbranch_scc0 L_prep_n1
    v_mov_b32 v32, v33
    v_mov_b32 v34, v35
    v_mov_b32 v36, v37
    v_mov_b32 v38, v39
    v_mov_b32 v40, v41
    v_mov_b32 v42, v43
    v_mov_b32 v44, v45
    v_mov_b32 v46, v47
    v_mov_b32 v48, v49
    v_mov_b32 v50, v51
    v_mov_b32 v52, v53
    v_mov_b32 v54, v55
    v_mov_b32 v56, v57
    v_mov_b32 v58, v59
    v_mov_b32 v60, v61
    v_mov_b32 v62, v63
    v_mov_b32 v64, v65
    v_mov_b32 v66, v67
    v_mov_b32 v68, v69
    v_mov_b32 v70, v74
    v_mov_b32 v71, v75
    v_mov_b32 v72, v76
    v_mov_b32 v73, v77
    v_add_u32 v7, 128, v7
    s_mov_b32 s37, 1
    s_branch L_prep_u
L_prep_n1:
    s_cmp_eq_u32 s37, 1
    s_cbranch_scc0 L_prep_done
    s_cmp_lt_u32 s10, 2
    s_cbranch_scc0 L_prep_done
    v_lshrrev_b32 v3, 2, v1
    v_add_u32 v3, 128, v3
    v_and_b32 v5, 3, v1
    v_mul_u32_u24 v5, 9216, v5
    v_lshl_add_u32 v5, v3, 3, v5
    s_lshl_b32 s37, s10, 2
    v_add_u32 v5, s37, v5
    ds_read_b32 v32, v5 offset:0
    ds_read_b32 v34, v5 offset:1152
    ds_read_b32 v36, v5 offset:2304
    ds_read_b32 v38, v5 offset:3456
    ds_read_b32 v40, v5 offset:4608
    ds_read_b32 v42, v5 offset:5760
    ds_read_b32 v44, v5 offset:6912
    ds_read_b32 v46, v5 offset:8064
    ds_read_b32 v48, v5 offset:9216
    ds_read_b32 v50, v5 offset:10368
    ds_read_b32 v52, v5 offset:11520
    s_waitcnt lgkmcnt(4)
    ds_read_b32 v54, v5 offset:40960
    ds_read_b32 v56, v5 offset:42112
    ds_read_b32 v58, v5 offset:43264
    ds_read_b32 v60, v5 offset:44416
    ds_read_b32 v62, v5 offset:45568
    ds_read_b32 v64, v5 offset:46720
    ds_read_b32 v66, v5 offset:47872
    ds_read_b32 v68, v5 offset:49024
    v_mul_u32_u24 v2, 1821, v3
    v_lshrrev_b32 v2, 16, v2
    v_mul_u32_u24 v7, 36, v2
    v_sub_u32 v7, v3, v7
    v_mul_u32_u24 v2, 9216, v2
    v_lshl_add_u32 v7, v7, 8, v2
    v_add_u32 v7, v7, v4
    s_lshl_b32 s37, s10, 7
    v_add_u32 v7, s37, v7
    v_mov_b32 v70, v78
    v_mov_b32 v71, v79
    v_mov_b32 v72, v80
    v_mov_b32 v73, v81
    s_waitcnt lgkmcnt(0)
    s_mov_b32 s37, 2
    s_branch L_prep_u
L_prep_done:
    v_and_b32 v10, 15, v1
    v_lshrrev_b32 v11, 4, v1
    s_lshl_b32 s36, s33, 5
    s_lshl_b32 s37, s10, 2
    s_add_u32 s36, s36, s37
    v_add_u32 v12, s36, v11
    v_mul_u32_u24 v13, 1152, v12
    v_lshl_add_u32 v13, v10, 4, v13
    v_lshlrev_b32 v14, 4, v10
    s_nop 1
    buffer_load_dwordx4 v[32:35], v13, s[48:51], 0 offen offset:0
    buffer_load_dwordx4 v[52:55], v14, s[52:55], 0 offen offset:0
    buffer_load_dwordx4 v[36:39], v13, s[48:51], 0 offen offset:256
    buffer_load_dwordx4 v[56:59], v14, s[52:55], 0 offen offset:256
    buffer_load_dwordx4 v[40:43], v13, s[48:51], 0 offen offset:512
    buffer_load_dwordx4 v[60:63], v14, s[52:55], 0 offen offset:512
    buffer_load_dwordx4 v[44:47], v13, s[48:51], 0 offen offset:768
    buffer_load_dwordx4 v[64:67], v14, s[52:55], 0 offen offset:768
    v_mov_b32 v48, 0
    v_mov_b32 v68, 0
    v_mov_b32 v49, 0
    v_mov_b32 v69, 0
    v_mov_b32 v50, 0
    v_mov_b32 v70, 0
    v_mov_b32 v51, 0
    v_mov_b32 v71, 0
    v_cmp_gt_u32 vcc, 8, v10
    s_and_saveexec_b64 s[40:41], vcc
    buffer_load_dwordx4 v[48:51], v13, s[48:51], 0 offen offset:1024
    buffer_load_dwordx4 v[68:71], v14, s[52:55], 0 offen offset:1024
    s_mov_b64 exec, s[40:41]
    s_waitcnt vmcnt(10)
    s_barrier
    s_lshl_b32 s14, s33, 2
    s_add_u32 s14, s14, 15368192
    s_cmp_eq_u32 s10, 0
    s_cbranch_scc0 L_flag2
    v_mov_b32 v2, s3
    v_mul_u32_u24 v3, 256, v1
    s_mov_b64 s[40:41], exec
    s_mov_b32 exec_lo, 0xffffffff
    s_mov_b32 exec_hi, 0
    buffer_store_dword v2, v3, s[4:7], s14 offen sc1
    s_mov_b64 exec, s[40:41]
L_flag2:
    s_cmp_ge_u32 s10, 4
    s_cbranch_scc1 L_x_noh
    s_mov_b32 s24, s78
    s_mov_b32 s25, s79
    s_mov_b32 s26, 2359296
    s_mov_b32 s27, 0x20000
    s_lshl_b32 s42, s34, 12
    s_sub_u32 s42, s42, 8
    v_lshlrev_b32 v2, 4, v0
    v_add_u32 v3, s42, v2
    v_add_u32 v4, 16, v3
    buffer_load_dwordx4 v[136:139], v3, s[24:27], 0 offen
    buffer_load_dwordx2 v[140:141], v4, s[24:27], 0 offen
    v_add_u32 v3, 4096, v3
    v_add_u32 v4, 16, v3
    buffer_load_dwordx4 v[142:145], v3, s[24:27], 0 offen
    buffer_load_dwordx2 v[146:147], v4, s[24:27], 0 offen
    v_add_u32 v3, 4096, v3
    s_cmp_eq_u32 s35, 3
    s_cbranch_scc0 L_hl_skipx
    v_add_u32 v4, 16, v3
    buffer_load_dwordx4 v[148:151], v3, s[24:27], 0 offen
    buffer_load_dwordx2 v[152:153], v4, s[24:27], 0 offen
L_hl_skipx:
L_x_noh:
    s_mov_b32 s44, s68
    s_mov_b32 s45, s69
    s_mov_b32 s46, 663552
    s_mov_b32 s47, 0x20000
    v_and_b32 v2, 15, v1
    v_lshrrev_b32 v3, 4, v1
    v_lshrrev_b32 v4, 1, v3
    v_mul_u32_u24 v4, 20, v4
    v_and_b32 v5, 1, v3
    v_lshl_add_u32 v4, v5, 3, v4
    v_mul_u32_u24 v5, 72, v3
    v_lshlrev_b32 v7, 4, v1
    s_lshl_b32 s16, s10, 6
    s_add_u32 s16, s16, s33
    s_lshl_b32 s20, s16, 10
    s_add_u32 s20, s20, 14704640
    s_cmp_ge_u32 s16, 648
    s_cselect_b32 s20, 0x7f000000, s20
    s_min_u32 s16, s16, 647
    s_mul_i32 s15, s16, 1821
    s_lshr_b32 s15, s15, 16
    s_mul_i32 s17, s15, 36
    s_sub_u32 s16, s16, s17
    s_sub_u32 s18, s15, 16
    s_mul_i32 s18, s18, 288
    s_cmp_lt_u32 s15, 16
    s_cselect_b64 vcc, -1, 0
    s_cselect_b32 s17, s17, s18
    v_cndmask_b32 v6, v5, v4, vcc
    v_add_u32 v6, s17, v6
    v_mul_u32_u24 v6, 1152, v6
    s_lshl_b32 s16, s16, 5
    v_lshl_add_u32 v6, v2, 1, v6
    v_add_u32 v6, s16, v6
    s_cmp_lt_u32 s15, 16
    s_movk_i32 s19, 0
    s_cselect_b32 s18, s19, 18432
    buffer_load_ushort v72, v6, s[44:47], s18 offen
    s_movk_i32 s19, 1152
    s_cselect_b32 s18, s19, 19584
    buffer_load_ushort v73, v6, s[44:47], s18 offen
    s_movk_i32 s19, 2304
    s_cselect_b32 s18, s19, 20736
    buffer_load_ushort v74, v6, s[44:47], s18 offen
    s_movk_i32 s19, 3456
    s_cselect_b32 s18, s19, 21888
    buffer_load_ushort v75, v6, s[44:47], s18 offen
    s_movk_i32 s19, 4608
    s_cselect_b32 s18, s19, 59904
    buffer_load_ushort v76, v6, s[44:47], s18 offen
    s_movk_i32 s19, 5760
    s_cselect_b32 s18, s19, 61056
    buffer_load_ushort v77, v6, s[44:47], s18 offen
    s_movk_i32 s19, 6912
    s_cselect_b32 s18, s19, 62208
    buffer_load_ushort v78, v6, s[44:47], s18 offen
    s_movk_i32 s19, 8064
    s_cselect_b32 s18, s19, 63360
    buffer_load_ushort v79, v6, s[44:47], s18 offen
    s_lshl_b32 s16, s10, 6
    s_add_u32 s16, s16, s33
    s_add_u32 s16, s16, 512
    s_lshl_b32 s21, s16, 10
    s_add_u32 s21, s21, 14704640
    s_cmp_ge_u32 s16, 648
    s_cselect_b32 s21, 0x7f000000, s21
    s_min_u32 s16, s16, 647
    s_mul_i32 s15, s16, 1821
    s_lshr_b32 s15, s15, 16
    s_mul_i32 s17, s15, 36
    s_sub_u32 s16, s16, s17
    s_sub_u32 s18, s15, 16
    s_mul_i32 s18, s18, 288
    s_cmp_lt_u32 s15, 16
    s_cselect_b64 vcc, -1, 0
    s_cselect_b32 s17, s17, s18
    v_cndmask_b32 v6, v5, v4, vcc
    v_add_u32 v6, s17, v6
    v_mul_u32_u24 v6, 1152, v6
    s_lshl_b32 s16, s16, 5
    v_lshl_add_u32 v6, v2, 1, v6
    v_add_u32 v6, s16, v6
    s_cmp_lt_u32 s15, 16
    s_movk_i32 s19, 0
    s_cselect_b32 s18, s19, 18432
    buffer_load_ushort v80, v6, s[44:47], s18 offen
    s_movk_i32 s19, 1152
    s_cselect_b32 s18, s19, 19584
    buffer_load_ushort v81, v6, s[44:47], s18 offen
    s_movk_i32 s19, 2304
    s_cselect_b32 s18, s19, 20736
    buffer_load_ushort v82, v6, s[44:47], s18 offen
    s_movk_i32 s19, 3456
    s_cselect_b32 s18, s19, 21888
    buffer_load_ushort v83, v6, s[44:47], s18 offen
    s_movk_i32 s19, 4608
    s_cselect_b32 s18, s19, 59904
    buffer_load_ushort v84, v6, s[44:47], s18 offen
    s_movk_i32 s19, 5760
    s_cselect_b32 s18, s19, 61056
    buffer_load_ushort v85, v6, s[44:47], s18 offen
    s_movk_i32 s19, 6912
    s_cselect_b32 s18, s19, 62208
    buffer_load_ushort v86, v6, s[44:47], s18 offen
    s_movk_i32 s19, 8064
    s_cselect_b32 s18, s19, 63360
    buffer_load_ushort v87, v6, s[44:47], s18 offen
    s_waitcnt vmcnt(0)
    v_mov_b32 v15, 0
    v_dot2_f32_bf16 v15, v32, v52, v15
    v_dot2_f32_bf16 v15, v33, v53, v15
    v_dot2_f32_bf16 v15, v34, v54, v15
    v_dot2_f32_bf16 v15, v35, v55, v15
    v_dot2_f32_bf16 v15, v36, v56, v15
    v_dot2_f32_bf16 v15, v37, v57, v15
    v_dot2_f32_bf16 v15, v38, v58, v15
    v_dot2_f32_bf16 v15, v39, v59, v15
    v_dot2_f32_bf16 v15, v40, v60, v15
    v_dot2_f32_bf16 v15, v41, v61, v15
    v_dot2_f32_bf16 v15, v42, v62, v15
    v_dot2_f32_bf16 v15, v43, v63, v15
    v_dot2_f32_bf16 v15, v44, v64, v15
    v_dot2_f32_bf16 v15, v45, v65, v15
    v_dot2_f32_bf16 v15, v46, v66, v15
    v_dot2_f32_bf16 v15, v47, v67, v15
    v_dot2_f32_bf16 v15, v48, v68, v15
    v_dot2_f32_bf16 v15, v49, v69, v15
    v_dot2_f32_bf16 v15, v50, v70, v15
    v_dot2_f32_bf16 v15, v51, v71, v15
    s_nop 3
    s_nop 1
    v_add_f32_dpp v15, v15, v15 row_ror:8 row_mask:0xf bank_mask:0xf
    s_nop 1
    v_add_f32_dpp v15, v15, v15 row_ror:4 row_mask:0xf bank_mask:0xf
    s_nop 1
    v_add_f32_dpp v15, v15, v15 row_ror:2 row_mask:0xf bank_mask:0xf
    s_nop 1
    v_add_f32_dpp v15, v15, v15 row_ror:1 row_mask:0xf bank_mask:0xf
    v_mul_f32 v15, 0xbfb8aa3b, v15
    v_exp_f32 v15, v15
    s_mov_b32 s36, 7618560
    v_add_f32 v15, 1.0, v15
    v_rcp_f32 v15, v15
    v_lshlrev_b32 v12, 2, v12
    v_cmp_eq_u32 vcc, 0, v10
    s_and_saveexec_b64 s[40:41], vcc
    buffer_store_dword v15, v12, s[4:7], s36 offen sc1
    s_mov_b64 exec, s[40:41]
    v_lshlrev_b32 v7, 4, v1
    v_lshl_or_b32 v88, v73, 16, v72
    v_lshl_or_b32 v89, v75, 16, v74
    v_lshl_or_b32 v90, v77, 16, v76
    v_lshl_or_b32 v91, v79, 16, v78
    buffer_store_dwordx4 v[88:91], v7, s[4:7], s20 offen sc1
    v_lshl_or_b32 v92, v81, 16, v80
    v_lshl_or_b32 v93, v83, 16, v82
    v_lshl_or_b32 v94, v85, 16, v84
    v_lshl_or_b32 v95, v87, 16, v86
    buffer_store_dwordx4 v[92:95], v7, s[4:7], s21 offen sc1
    s_cmp_ge_u32 s10, 4
    s_cbranch_scc1 L_x_u
    v_mov_b32 v156, 0
    v_mov_b32 v157, 0
    v_mov_b32 v158, 0
    v_mov_b32 v159, 0
    v_lshrrev_b32 v2, 2, v0
    v_mul_u32_u24 v3, 4160, v2
    v_and_b32 v5, 3, v0
    v_lshl_add_u32 v3, v5, 4, v3
    v_add_u32 v3, s98, v3
    v_cmp_gt_u32 vcc, 16, v0
    s_and_saveexec_b64 s[56:57], vcc
    ds_write_b128 v3, v[156:159] offset:0
    ds_write_b128 v3, v[156:159] offset:23040
    s_cmp_eq_u32 s35, 3
    s_cbranch_scc0 L_hzx
    ds_write_b128 v3, v[156:159] offset:46080
L_hzx:
    s_mov_b64 exec, s[56:57]
    v_lshlrev_b32 v2, 4, v0
    v_add_u32 v2, s98, v2
    v_cmp_ne_u32 vcc, 0, v0
    v_cndmask_b32 v136, 0, v136, vcc
    v_cndmask_b32 v137, 0, v137, vcc
    v_alignbit_b32 v156, v137, v136, 16
    v_alignbit_b32 v157, v138, v137, 16
    v_alignbit_b32 v158, v139, v138, 16
    v_alignbit_b32 v159, v140, v139, 16
    v_alignbit_b32 v160, v141, v140, 16
    ds_write_b128 v2, v[156:159] offset:64
    v_mov_b32 v164, v137
    v_mov_b32 v165, v138
    v_mov_b32 v166, v139
    v_mov_b32 v167, v140
    v_mov_b32 v168, v157
    v_mov_b32 v169, v158
    v_mov_b32 v170, v159
    v_mov_b32 v171, v160
    ds_write_b128 v2, v[164:167] offset:4224
    ds_write_b128 v2, v[168:171] offset:8384
    ds_write_b128 v2, v[138:141] offset:12544
    v_cndmask_b32 v142, 0, v142, vcc
    v_cndmask_b32 v143, 0, v143, vcc
    v_alignbit_b32 v156, v143, v142, 16
    v_alignbit_b32 v157, v144, v143, 16
    v_alignbit_b32 v158, v145, v144, 16
    v_alignbit_b32 v159, v146, v145, 16
    v_alignbit_b32 v160, v147, v146, 16
    ds_write_b128 v2, v[156:159] offset:23104
    v_mov_b32 v164, v143
    v_mov_b32 v165, v144
    v_mov_b32 v166, v145
    v_mov_b32 v167, v146
    v_mov_b32 v168, v157
    v_mov_b32 v169, v158
    v_mov_b32 v170, v159
    v_mov_b32 v171, v160
    ds_write_b128 v2, v[164:167] offset:27264
    ds_write_b128 v2, v[168:171] offset:31424
    ds_write_b128 v2, v[144:147] offset:35584
    s_cmp_eq_u32 s35, 3
    s_cbranch_scc0 L_hpx
    v_cndmask_b32 v148, 0, v148, vcc
    v_cndmask_b32 v149, 0, v149, vcc
    v_alignbit_b32 v156, v149, v148, 16
    v_alignbit_b32 v157, v150, v149, 16
    v_alignbit_b32 v158, v151, v150, 16
    v_alignbit_b32 v159, v152, v151, 16
    v_alignbit_b32 v160, v153, v152, 16
    ds_write_b128 v2, v[156:159] offset:46144
    v_mov_b32 v164, v149
    v_mov_b32 v165, v150
    v_mov_b32 v166, v151
    v_mov_b32 v167, v152
    v_mov_b32 v168, v157
    v_mov_b32 v169, v158
    v_mov_b32 v170, v159
    v_mov_b32 v171, v160
    ds_write_b128 v2, v[164:167] offset:50304
    ds_write_b128 v2, v[168:171] offset:54464
    ds_write_b128 v2, v[150:153] offset:58624
L_hpx:
    s_branch L_afterA
L_x_u:
    s_lshr_b32 s46, s2, 3
    s_lshl_b32 s46, s46, 8
    s_add_u32 s46, s46, 15368192
    v_lshlrev_b32 v2, 2, v1
    s_mov_b64 s[40:41], exec
    s_mov_b32 s42, 20000
L_poll3:
    buffer_load_dword v4, v2, s[4:7], s46 offen sc1
    s_waitcnt vmcnt(0)
    v_cmp_ne_u32 vcc, s3, v4
    s_nop 3
    s_cmp_eq_u64 vcc, 0
    s_cbranch_scc1 L_poll3_d
    s_sub_u32 s42, s42, 1
    s_cmp_lg_u32 s42, 0
    s_cbranch_scc1 L_poll3
L_poll3_d:
    s_mov_b64 exec, s[40:41]
L_poll3_e:
    v_subrev_u32 v7, 256, v0
    s_mul_i32 s43, s34, 7282
    s_lshr_b32 s43, s43, 20
    s_mul_i32 s48, s43, 144
    s_sub_u32 s48, s34, s48
    s_mul_i32 s43, s43, 9216
    s_lshl_b32 s48, s48, 6
    s_add_u32 s43, s43, s48
    s_add_u32 s43, s43, 9949184
    v_lshrrev_b32 v2, 2, v7
    v_and_b32 v3, 3, v7
    v_mul_u32_u24 v4, 36864, v2
    v_lshlrev_b32 v5, 4, v3
    v_sub_u32 v4, v5, v4
    v_add_u32 v4, s43, v4
    buffer_load_dwordx4 v[176:179], v4, s[4:7], 0 offen offset:0
    buffer_load_dwordx4 v[180:183], v4, s[4:7], 0 offen offset:64
    s_cmp_eq_u32 s35, 3
    s_cbranch_scc0 L_ul_skipx
    buffer_load_dwordx4 v[184:187], v4, s[4:7], 0 offen offset:128
L_ul_skipx:
    v_lshrrev_b32 v6, 2, v2
    v_lshrrev_b32 v5, 1, v3
    v_xor_b32 v6, v6, v5
    v_and_b32 v6, 1, v6
    v_and_b32 v5, 1, v3
    v_lshl_add_u32 v6, v5, 1, v6
    v_lshlrev_b32 v6, 4, v6
    v_lshl_add_u32 v6, v2, 6, v6
    s_add_u32 s48, s98, 16640
    v_add_u32 v6, s48, v6
    v_mov_b32 v24, 0
    v_mov_b32 v25, 0
    v_mov_b32 v26, 0
    v_mov_b32 v27, 0
    v_cmp_gt_u32 vcc, 60, v7
    s_and_saveexec_b64 s[44:45], vcc
    ds_write_b128 v6, v[24:27] offset:4096
    ds_write_b128 v6, v[24:27] offset:27136
    s_cmp_eq_u32 s35, 3
    s_cbranch_scc0 L_uzx
    ds_write_b128 v6, v[24:27] offset:50176
L_uzx:
    s_mov_b64 exec, s[44:45]
    s_waitcnt vmcnt(0)
    ds_write_b128 v6, v[176:179] offset:0
    ds_write_b128 v6, v[180:183] offset:23040
    s_cmp_eq_u32 s35, 3
    s_cbranch_scc0 L_uwx
    ds_write_b128 v6, v[184:187] offset:46080
L_uwx:
L_afterA:
    s_mov_b32 s49, s10
    s_lshl_b32 s50, s35, 2
    s_mov_b32 s51, 0
    s_lshr_b32 s39, s49, 2
    s_bfe_u32 s52, s49, 0x10001
    s_and_b32 s53, s49, 1
    s_add_u32 s40, s34, s39
    s_lshl_b32 s40, s40, 1
    s_and_b32 s55, s40, 0xfffffffc
    s_load_dword s56, s[80:81], s55
    s_mul_i32 s41, s39, 23040
    s_add_u32 s41, s41, s98
    v_and_b32 v2, 15, v1
    v_lshrrev_b32 v3, 4, v1
    v_sub_u32 v130, 15, v2
    s_lshl_b32 s54, s53, 3
    v_add_u32 v130, s54, v130
    v_lshrrev_b32 v132, 1, v3
    v_and_b32 v131, 1, v3
    v_lshlrev_b32 v131, 5, v131
    s_add_u32 s54, s41, 16640
    v_add_u32 v131, s54, v131
    v_lshrrev_b32 v4, 2, v2
    v_mul_u32_u24 v4, 4160, v4
    v_lshl_add_u32 v4, v3, 4, v4
    v_and_b32 v5, 3, v1
    v_lshl_add_u32 v4, v5, 3, v4
    s_lshl_b32 s54, s52, 5
    s_lshl_b32 s55, s53, 9
    s_add_u32 s54, s54, s55
    s_add_u32 s54, s54, s41
    s_add_u32 s54, s54, 8
    v_add_u32 v8, s54, v4
    v_mov_b32 v80, 0
    v_mov_b32 v81, 0
    v_mov_b32 v82, 0
    v_mov_b32 v83, 0
    v_mov_b32 v84, 0
    v_mov_b32 v85, 0
    v_mov_b32 v86, 0
    v_mov_b32 v87, 0
    v_mov_b32 v88, 0
    v_mov_b32 v89, 0
    v_mov_b32 v90, 0
    v_mov_b32 v91, 0
    v_mov_b32 v92, 0
    v_mov_b32 v93, 0
    v_mov_b32 v94, 0
    v_mov_b32 v95, 0
    s_lshl_b32 s54, s52, 4
    s_sub_u32 s54, 31, s54
    v_sub_u32 v4, s54, v2
    v_lshlrev_b32 v5, 3, v3
    v_sub_u32 v4, v4, v5
    s_waitcnt lgkmcnt(0)
    s_bitcmp1_b32 s40, 1
    s_cselect_b32 s57, 16, 0
    s_lshr_b32 s56, s56, s57
    s_and_b32 s56, s56, 0xffff
    s_cmp_eq_u32 s53, 0
    s_cselect_b32 s56, s56, 0
    s_lshl_b32 s57, s56, 16
    v_mov_b32 v6, s56
    v_mov_b32 v7, s57
    v_cmp_eq_u32 vcc, 0, v4
    v_cmp_eq_u32 s[58:59], 1, v4
    s_nop 1
    v_cndmask_b32 v14, 0, v6, vcc
    v_cndmask_b32 v15, 0, v7, s[58:59]
    v_or_b32 v10, v14, v15
    v_cmp_eq_u32 vcc, 2, v4
    v_cmp_eq_u32 s[58:59], 3, v4
    s_nop 1
    v_cndmask_b32 v14, 0, v6, vcc
    v_cndmask_b32 v15, 0, v7, s[58:59]
    v_or_b32 v11, v14, v15
    v_cmp_eq_u32 vcc, 4, v4
    v_cmp_eq_u32 s[58:59], 5, v4
    s_nop 1
    v_cndmask_b32 v14, 0, v6, vcc
    v_cndmask_b32 v15, 0, v7, s[58:59]
    v_or_b32 v12, v14, v15
    v_cmp_eq_u32 vcc, 6, v4
    v_cmp_eq_u32 s[58:59], 7, v4
    s_nop 1
    v_cndmask_b32 v14, 0, v6, vcc
    v_cndmask_b32 v15, 0, v7, s[58:59]
    v_or_b32 v13, v14, v15
    s_waitcnt vmcnt(0) lgkmcnt(0)
    s_barrier
    s_cmp_eq_u32 s32, 1
    s_cbranch_scc1 L_nof1
    s_lshl_b32 s14, s9, 8
    s_lshl_b32 s15, s11, 6
    s_add_u32 s14, s14, s15
    s_lshl_b32 s15, s8, 2
    s_add_u32 s14, s14, s15
    s_add_u32 s14, s14, 15376384
    s_cmp_eq_u32 s10, 0
    s_cbranch_scc0 L_flag4
    v_mov_b32 v2, s3
    v_mul_u32_u24 v3, 1024, v1
    s_mov_b64 s[40:41], exec
    s_mov_b32 exec_lo, 0xf
    s_mov_b32 exec_hi, 0
    buffer_store_dword v2, v3, s[4:7], s14 offen sc1
    s_mov_b64 exec, s[40:41]
L_flag4:
L_nof1:
    s_cmp_eq_u32 s32, 0
    s_cbranch_scc0 L_noknorm
    s_cmp_eq_u32 s11, 1
    s_cbranch_scc0 L_noknorm
    s_cmp_lt_u32 s10, 4
    s_cbranch_scc0 L_noknorm
    v_and_b32 v2, 15, v1
    v_lshrrev_b32 v3, 4, v1
    v_dot2_f32_bf16 v64, v16, v16, 0
    v_dot2_f32_bf16 v65, v18, v18, 0
    v_dot2_f32_bf16 v66, v20, v20, 0
    v_dot2_f32_bf16 v67, v22, v22, 0
    v_dot2_f32_bf16 v68, v24, v24, 0
    v_dot2_f32_bf16 v69, v26, v26, 0
    v_dot2_f32_bf16 v70, v28, v28, 0
    v_dot2_f32_bf16 v71, v30, v30, 0
    v_dot2_f32_bf16 v72, v32, v32, 0
    v_dot2_f32_bf16 v73, v34, v34, 0
    v_dot2_f32_bf16 v74, v36, v36, 0
    v_dot2_f32_bf16 v75, v38, v38, 0
    v_dot2_f32_bf16 v76, v40, v40, 0
    v_dot2_f32_bf16 v77, v42, v42, 0
    v_dot2_f32_bf16 v78, v44, v44, 0
    v_dot2_f32_bf16 v79, v46, v46, 0
    v_dot2_f32_bf16 v64, v17, v17, v64
    v_dot2_f32_bf16 v65, v19, v19, v65
    v_dot2_f32_bf16 v66, v21, v21, v66
    v_dot2_f32_bf16 v67, v23, v23, v67
    v_dot2_f32_bf16 v68, v25, v25, v68
    v_dot2_f32_bf16 v69, v27, v27, v69
    v_dot2_f32_bf16 v70, v29, v29, v70
    v_dot2_f32_bf16 v71, v31, v31, v71
    v_dot2_f32_bf16 v72, v33, v33, v72
    v_dot2_f32_bf16 v73, v35, v35, v73
    v_dot2_f32_bf16 v74, v37, v37, v74
    v_dot2_f32_bf16 v75, v39, v39, v75
    v_dot2_f32_bf16 v76, v41, v41, v76
    v_dot2_f32_bf16 v77, v43, v43, v77
    v_dot2_f32_bf16 v78, v45, v45, v78
    v_dot2_f32_bf16 v79, v47, v47, v79
    v_dot2_f32_bf16 v80, v48, v48, 0
    v_dot2_f32_bf16 v81, v49, v49, 0
    v_dot2_f32_bf16 v82, v50, v50, 0
    v_dot2_f32_bf16 v83, v51, v51, 0
    s_nop 2
    v_permlane16_swap_b32 v80, v81
    v_permlane16_swap_b32 v82, v83
    s_nop 1
    v_permlane32_swap_b32 v80, v81
    v_permlane32_swap_b32 v82, v83
    v_permlane16_swap_b32 v64, v66
    v_permlane16_swap_b32 v68, v70
    s_nop 0
    v_add_f32 v64, v64, v66
    v_add_f32 v68, v68, v70
    s_nop 1
    v_permlane32_swap_b32 v64, v68
    s_nop 0
    v_add_f32 v88, v64, v68
    v_add_f32 v88, v88, v80
    v_permlane16_swap_b32 v65, v67
    v_permlane16_swap_b32 v69, v71
    s_nop 0
    v_add_f32 v65, v65, v67
    v_add_f32 v69, v69, v71
    s_nop 1
    v_permlane32_swap_b32 v65, v69
    s_nop 0
    v_add_f32 v89, v65, v69
    v_add_f32 v89, v89, v82
    v_permlane16_swap_b32 v72, v74
    v_permlane16_swap_b32 v76, v78
    s_nop 0
    v_add_f32 v72, v72, v74
    v_add_f32 v76, v76, v78
    s_nop 1
    v_permlane32_swap_b32 v72, v76
    s_nop 0
    v_add_f32 v90, v72, v76
    v_add_f32 v90, v90, v81
    v_permlane16_swap_b32 v73, v75
    v_permlane16_swap_b32 v77, v79
    s_nop 0
    v_add_f32 v73, v73, v75
    v_add_f32 v77, v77, v79
    s_nop 1
    v_permlane32_swap_b32 v73, v77
    s_nop 0
    v_add_f32 v91, v73, v77
    v_add_f32 v91, v91, v83
    v_max_f32 v88, v88, v89
    v_max_f32 v90, v90, v91
    s_nop 0
    v_max_f32_dpp v88, v88, v88 row_ror:8 row_mask:0xf bank_mask:0xf
    v_max_f32_dpp v90, v90, v90 row_ror:8 row_mask:0xf bank_mask:0xf
    s_nop 0
    v_max_f32_dpp v88, v88, v88 row_ror:4 row_mask:0xf bank_mask:0xf
    v_max_f32_dpp v90, v90, v90 row_ror:4 row_mask:0xf bank_mask:0xf
    s_nop 0
    v_max_f32_dpp v88, v88, v88 row_ror:2 row_mask:0xf bank_mask:0xf
    v_max_f32_dpp v90, v90, v90 row_ror:2 row_mask:0xf bank_mask:0xf
    s_nop 0
    v_max_f32_dpp v88, v88, v88 row_ror:1 row_mask:0xf bank_mask:0xf
    v_max_f32_dpp v90, v90, v90 row_ror:1 row_mask:0xf bank_mask:0xf
    v_lshlrev_b32 v6, 9, v3
    s_lshl_b32 s14, s8, 2
    s_add_u32 s14, s14, s10
    s_lshl_b32 s54, s9, 12
    s_lshl_b32 s55, s14, 3
    s_add_u32 s54, s54, s55
    s_add_u32 s54, s54, 7602176
    v_mov_b32 v89, s3
    v_mov_b32 v91, s3
    v_cmp_eq_u32 vcc, 0, v2
    s_and_saveexec_b64 s[40:41], vcc
    buffer_store_dwordx2 v[88:89], v6, s[4:7], s54 offen sc1
    buffer_store_dwordx2 v[90:91], v6, s[4:7], s54 offen offset:2048 sc1
    s_mov_b64 exec, s[40:41]
    s_mov_b32 s49, s10
    s_lshl_b32 s50, s35, 2
    s_mov_b32 s51, 0
    s_lshr_b32 s39, s49, 2
    s_bfe_u32 s52, s49, 0x10001
    s_and_b32 s53, s49, 1
    s_add_u32 s40, s34, s39
    s_lshl_b32 s40, s40, 1
    s_and_b32 s55, s40, 0xfffffffc
    s_load_dword s56, s[80:81], s55
    s_mul_i32 s41, s39, 23040
    s_add_u32 s41, s41, s98
    v_and_b32 v2, 15, v1
    v_lshrrev_b32 v3, 4, v1
    v_sub_u32 v130, 15, v2
    s_lshl_b32 s54, s53, 3
    v_add_u32 v130, s54, v130
    v_lshrrev_b32 v132, 1, v3
    v_and_b32 v131, 1, v3
    v_lshlrev_b32 v131, 5, v131
    s_add_u32 s54, s41, 16640
    v_add_u32 v131, s54, v131
    v_lshrrev_b32 v4, 2, v2
    v_mul_u32_u24 v4, 4160, v4
    v_lshl_add_u32 v4, v3, 4, v4
    v_and_b32 v5, 3, v1
    v_lshl_add_u32 v4, v5, 3, v4
    s_lshl_b32 s54, s52, 5
    s_lshl_b32 s55, s53, 9
    s_add_u32 s54, s54, s55
    s_add_u32 s54, s54, s41
    s_add_u32 s54, s54, 8
    v_add_u32 v8, s54, v4
    v_mov_b32 v80, 0
    v_mov_b32 v81, 0
    v_mov_b32 v82, 0
    v_mov_b32 v83, 0
    v_mov_b32 v84, 0
    v_mov_b32 v85, 0
    v_mov_b32 v86, 0
    v_mov_b32 v87, 0
    v_mov_b32 v88, 0
    v_mov_b32 v89, 0
    v_mov_b32 v90, 0
    v_mov_b32 v91, 0
    v_mov_b32 v92, 0
    v_mov_b32 v93, 0
    v_mov_b32 v94, 0
    v_mov_b32 v95, 0
    s_lshl_b32 s54, s52, 4
    s_sub_u32 s54, 31, s54
    v_sub_u32 v4, s54, v2
    v_lshlrev_b32 v5, 3, v3
    v_sub_u32 v4, v4, v5
    s_waitcnt lgkmcnt(0)
    s_bitcmp1_b32 s40, 1
    s_cselect_b32 s57, 16, 0
    s_lshr_b32 s56, s56, s57
    s_and_b32 s56, s56, 0xffff
    s_cmp_eq_u32 s53, 0
    s_cselect_b32 s56, s56, 0
    s_lshl_b32 s57, s56, 16
    v_mov_b32 v6, s56
    v_mov_b32 v7, s57
    v_cmp_eq_u32 vcc, 0, v4
    v_cmp_eq_u32 s[58:59], 1, v4
    s_nop 1
    v_cndmask_b32 v14, 0, v6, vcc
    v_cndmask_b32 v15, 0, v7, s[58:59]
    v_or_b32 v10, v14, v15
    v_cmp_eq_u32 vcc, 2, v4
    v_cmp_eq_u32 s[58:59], 3, v4
    s_nop 1
    v_cndmask_b32 v14, 0, v6, vcc
    v_cndmask_b32 v15, 0, v7, s[58:59]
    v_or_b32 v11, v14, v15
    v_cmp_eq_u32 vcc, 4, v4
    v_cmp_eq_u32 s[58:59], 5, v4
    s_nop 1
    v_cndmask_b32 v14, 0, v6, vcc
    v_cndmask_b32 v15, 0, v7, s[58:59]
    v_or_b32 v12, v14, v15
    v_cmp_eq_u32 vcc, 6, v4
    v_cmp_eq_u32 s[58:59], 7, v4
    s_nop 1
    v_cndmask_b32 v14, 0, v6, vcc
    v_cndmask_b32 v15, 0, v7, s[58:59]
    v_or_b32 v13, v14, v15
L_noknorm:
    s_branch L_unit_go
L_unit:
    s_lshr_b32 s39, s49, 2
    s_bfe_u32 s52, s49, 0x10001
    s_and_b32 s53, s49, 1
    s_add_u32 s40, s34, s39
    s_lshl_b32 s40, s40, 1
    s_and_b32 s55, s40, 0xfffffffc
    s_load_dword s56, s[80:81], s55
    s_mul_i32 s41, s39, 23040
    s_add_u32 s41, s41, s98
    v_and_b32 v2, 15, v1
    v_lshrrev_b32 v3, 4, v1
    v_sub_u32 v130, 15, v2
    s_lshl_b32 s54, s53, 3
    v_add_u32 v130, s54, v130
    v_lshrrev_b32 v132, 1, v3
    v_and_b32 v131, 1, v3
    v_lshlrev_b32 v131, 5, v131
    s_add_u32 s54, s41, 16640
    v_add_u32 v131, s54, v131
    v_lshrrev_b32 v4, 2, v2
    v_mul_u32_u24 v4, 4160, v4
    v_lshl_add_u32 v4, v3, 4, v4
    v_and_b32 v5, 3, v1
    v_lshl_add_u32 v4, v5, 3, v4
    s_lshl_b32 s54, s52, 5
    s_lshl_b32 s55, s53, 9
    s_add_u32 s54, s54, s55
    s_add_u32 s54, s54, s41
    s_add_u32 s54, s54, 8
    v_add_u32 v8, s54, v4
    v_mov_b32 v80, 0
    v_mov_b32 v81, 0
    v_mov_b32 v82, 0
    v_mov_b32 v83, 0
    v_mov_b32 v84, 0
    v_mov_b32 v85, 0
    v_mov_b32 v86, 0
    v_mov_b32 v87, 0
    v_mov_b32 v88, 0
    v_mov_b32 v89, 0
    v_mov_b32 v90, 0
    v_mov_b32 v91, 0
    v_mov_b32 v92, 0
    v_mov_b32 v93, 0
    v_mov_b32 v94, 0
    v_mov_b32 v95, 0
    s_lshl_b32 s54, s52, 4
    s_sub_u32 s54, 31, s54
    v_sub_u32 v4, s54, v2
    v_lshlrev_b32 v5, 3, v3
    v_sub_u32 v4, v4, v5
    s_waitcnt lgkmcnt(0)
    s_bitcmp1_b32 s40, 1
    s_cselect_b32 s57, 16, 0
    s_lshr_b32 s56, s56, s57
    s_and_b32 s56, s56, 0xffff
    s_cmp_eq_u32 s53, 0
    s_cselect_b32 s56, s56, 0
    s_lshl_b32 s57, s56, 16
    v_mov_b32 v6, s56
    v_mov_b32 v7, s57
    v_cmp_eq_u32 vcc, 0, v4
    v_cmp_eq_u32 s[58:59], 1, v4
    s_nop 1
    v_cndmask_b32 v14, 0, v6, vcc
    v_cndmask_b32 v15, 0, v7, s[58:59]
    v_or_b32 v10, v14, v15
    v_cmp_eq_u32 vcc, 2, v4
    v_cmp_eq_u32 s[58:59], 3, v4
    s_nop 1
    v_cndmask_b32 v14, 0, v6, vcc
    v_cndmask_b32 v15, 0, v7, s[58:59]
    v_or_b32 v11, v14, v15
    v_cmp_eq_u32 vcc, 4, v4
    v_cmp_eq_u32 s[58:59], 5, v4
    s_nop 1
    v_cndmask_b32 v14, 0, v6, vcc
    v_cndmask_b32 v15, 0, v7, s[58:59]
    v_or_b32 v12, v14, v15
    v_cmp_eq_u32 vcc, 6, v4
    v_cmp_eq_u32 s[58:59], 7, v4
    s_nop 1
    v_cndmask_b32 v14, 0, v6, vcc
    v_cndmask_b32 v15, 0, v7, s[58:59]
    v_or_b32 v13, v14, v15
L_unit_go:
    v_lshrrev_b32 v9, 2, v130
    v_xor_b32 v9, v9, v132
    v_and_b32 v9, 1, v9
    v_lshl_add_u32 v9, v9, 4, v131
    v_lshl_add_u32 v9, v130, 6, v9
    ds_read_b128 v[16:19], v9 offset:3072
    ds_read_b128 v[20:23], v9 offset:2048
    ds_read_b128 v[24:27], v9 offset:1024
    ds_read_b128 v[28:31], v9 offset:0
    ds_read_b64_tr_b16 v[32:33], v8 offset:0
    ds_read_b64_tr_b16 v[34:35], v8 offset:8
    ds_read_b64_tr_b16 v[36:37], v8 offset:1024
    ds_read_b64_tr_b16 v[38:39], v8 offset:1032
    ds_read_b64_tr_b16 v[40:41], v8 offset:2048
    ds_read_b64_tr_b16 v[42:43], v8 offset:2056
    ds_read_b64_tr_b16 v[44:45], v8 offset:3072
    ds_read_b64_tr_b16 v[46:47], v8 offset:3080
    v_add_u32 v130, 1, v130
    v_add_u32 v8, 64, v8
    s_waitcnt lgkmcnt(8)
    v_mfma_f32_16x16x32_bf16 v[80:83], v[10:13], v[16:19], v[80:83]
    v_mfma_f32_16x16x32_bf16 v[84:87], v[10:13], v[20:23], v[84:87]
    v_mfma_f32_16x16x32_bf16 v[88:91], v[10:13], v[24:27], v[88:91]
    v_mfma_f32_16x16x32_bf16 v[92:95], v[10:13], v[28:31], v[92:95]
    s_mov_b32 s54, 4
L_r:
    s_waitcnt lgkmcnt(0)
    v_lshrrev_b32 v9, 2, v130
    v_xor_b32 v9, v9, v132
    v_and_b32 v9, 1, v9
    v_lshl_add_u32 v9, v9, 4, v131
    v_lshl_add_u32 v9, v130, 6, v9
    ds_read_b128 v[48:51], v9 offset:3072
    ds_read_b128 v[52:55], v9 offset:2048
    ds_read_b128 v[56:59], v9 offset:1024
    ds_read_b128 v[60:63], v9 offset:0
    ds_read_b64_tr_b16 v[64:65], v8 offset:0
    ds_read_b64_tr_b16 v[66:67], v8 offset:8
    ds_read_b64_tr_b16 v[68:69], v8 offset:1024
    ds_read_b64_tr_b16 v[70:71], v8 offset:1032
    ds_read_b64_tr_b16 v[72:73], v8 offset:2048
    ds_read_b64_tr_b16 v[74:75], v8 offset:2056
    ds_read_b64_tr_b16 v[76:77], v8 offset:3072
    ds_read_b64_tr_b16 v[78:79], v8 offset:3080
    v_add_u32 v130, 1, v130
    v_add_u32 v8, 64, v8
    v_mfma_f32_16x16x32_bf16 v[80:83], v[32:35], v[16:19], v[80:83]
    v_mfma_f32_16x16x32_bf16 v[84:87], v[32:35], v[20:23], v[84:87]
    v_mfma_f32_16x16x32_bf16 v[88:91], v[32:35], v[24:27], v[88:91]
    v_mfma_f32_16x16x32_bf16 v[92:95], v[32:35], v[28:31], v[92:95]
    v_mfma_f32_16x16x32_bf16 v[84:87], v[36:39], v[16:19], v[84:87]
    v_mfma_f32_16x16x32_bf16 v[88:91], v[36:39], v[20:23], v[88:91]
    v_mfma_f32_16x16x32_bf16 v[92:95], v[36:39], v[24:27], v[92:95]
    v_mfma_f32_16x16x32_bf16 v[88:91], v[40:43], v[16:19], v[88:91]
    v_mfma_f32_16x16x32_bf16 v[92:95], v[40:43], v[20:23], v[92:95]
    v_mfma_f32_16x16x32_bf16 v[92:95], v[44:47], v[16:19], v[92:95]
    s_waitcnt lgkmcnt(0)
    v_lshrrev_b32 v9, 2, v130
    v_xor_b32 v9, v9, v132
    v_and_b32 v9, 1, v9
    v_lshl_add_u32 v9, v9, 4, v131
    v_lshl_add_u32 v9, v130, 6, v9
    ds_read_b128 v[16:19], v9 offset:3072
    ds_read_b128 v[20:23], v9 offset:2048
    ds_read_b128 v[24:27], v9 offset:1024
    ds_read_b128 v[28:31], v9 offset:0
    ds_read_b64_tr_b16 v[32:33], v8 offset:0
    ds_read_b64_tr_b16 v[34:35], v8 offset:8
    ds_read_b64_tr_b16 v[36:37], v8 offset:1024
    ds_read_b64_tr_b16 v[38:39], v8 offset:1032
    ds_read_b64_tr_b16 v[40:41], v8 offset:2048
    ds_read_b64_tr_b16 v[42:43], v8 offset:2056
    ds_read_b64_tr_b16 v[44:45], v8 offset:3072
    ds_read_b64_tr_b16 v[46:47], v8 offset:3080
    v_add_u32 v130, 1, v130
    v_add_u32 v8, 64, v8
    v_mfma_f32_16x16x32_bf16 v[80:83], v[64:67], v[48:51], v[80:83]
    v_mfma_f32_16x16x32_bf16 v[84:87], v[64:67], v[52:55], v[84:87]
    v_mfma_f32_16x16x32_bf16 v[88:91], v[64:67], v[56:59], v[88:91]
    v_mfma_f32_16x16x32_bf16 v[92:95], v[64:67], v[60:63], v[92:95]
    v_mfma_f32_16x16x32_bf16 v[84:87], v[68:71], v[48:51], v[84:87]
    v_mfma_f32_16x16x32_bf16 v[88:91], v[68:71], v[52:55], v[88:91]
    v_mfma_f32_16x16x32_bf16 v[92:95], v[68:71], v[56:59], v[92:95]
    v_mfma_f32_16x16x32_bf16 v[88:91], v[72:75], v[48:51], v[88:91]
    v_mfma_f32_16x16x32_bf16 v[92:95], v[72:75], v[52:55], v[92:95]
    v_mfma_f32_16x16x32_bf16 v[92:95], v[76:79], v[48:51], v[92:95]
    s_sub_u32 s54, s54, 1
    s_cmp_eq_u32 s54, 1
    s_cbranch_scc0 L_nomid
    s_cmp_eq_u32 s32, 0
    s_cbranch_scc0 L_nomid
    s_lshr_b32 s14, s60, 3
    s_lshl_b32 s14, s14, 8
    s_bfe_u32 s15, s2, 0x20003
    s_lshl_b32 s15, s15, 10
    s_add_u32 s14, s14, s15
    s_add_u32 s14, s14, 15376384
    s_cmp_eq_u32 s10, 7
    s_cbranch_scc0 L_poll5_e
    v_lshlrev_b32 v2, 2, v1
    v_cmp_lt_u32 vcc, 6, v1
    v_add_u32 v2, 64, v2
    v_add_u32 v3, 36, v2
    v_cndmask_b32 v2, v2, v3, vcc
    s_lshl_b32 s15, s61, 3
    s_sub_u32 s15, s15, 56
    v_lshlrev_b32 v3, 2, v1
    v_cmp_lt_u32 vcc, 13, v1
    v_add_u32 v3, s15, v3
    s_nop 0
    v_cndmask_b32 v2, v2, v3, vcc
    s_mov_b64 s[40:41], exec
    s_mov_b32 exec_lo, 0xffff
    s_mov_b32 exec_hi, 0
    s_mov_b32 s42, 20000
L_poll5:
    buffer_load_dword v4, v2, s[4:7], s14 offen sc1
    s_waitcnt vmcnt(0)
    v_cmp_ne_u32 vcc, s3, v4
    s_nop 3
    s_cmp_eq_u64 vcc, 0
    s_cbranch_scc1 L_poll5_d
    s_sub_u32 s42, s42, 1
    s_cmp_lg_u32 s42, 0
    s_cbranch_scc1 L_poll5
L_poll5_d:
    s_mov_b64 exec, s[40:41]
L_poll5_e:
    s_barrier
    v_lshlrev_b32 v119, 4, v1
    s_lshl_b32 s15, s61, 3
    s_add_u32 s15, s15, s10
    s_mul_i32 s16, s60, 73728
    s_mul_i32 s17, s15, 1152
    s_add_u32 s16, s16, s17
    s_add_u32 s16, s16, 5242880
    s_add_u32 s17, s16, 1024
    v_and_b32 v2, 31, v1
    v_lshlrev_b32 v2, 2, v2
    s_mul_i32 s62, s60, 155648
    s_lshl_b32 s63, s10, 10
    s_add_u32 s62, s62, s63
    s_mov_b32 s22, 3
L_dma0ag:
    s_mov_b32 m0, s63
    s_add_u32 s63, s63, 8192
    buffer_load_dwordx4 v119, s[4:7], s62 offen lds
    s_add_u32 s62, s62, 8192
    s_sub_u32 s22, s22, 1
    s_cmp_lg_u32 s22, 0
    s_cbranch_scc1 L_dma0ag
    buffer_load_dwordx4 v[112:115], v119, s[4:7], s16 offen
    buffer_load_dword v116, v2, s[4:7], s17 offen
    s_cmp_eq_u32 s10, 7
    s_cbranch_scc0 L_m2eg
    s_lshr_b32 s14, s60, 3
    s_lshl_b32 s14, s14, 8
    s_bfe_u32 s15, s2, 0x20003
    s_lshl_b32 s15, s15, 10
    s_add_u32 s14, s14, s15
    s_add_u32 s14, s14, 15376384
    v_lshlrev_b32 v2, 2, v1
    v_min_u32 v2, 188, v2
    buffer_load_dword v136, v2, s[4:7], s14 offen sc1
L_m2eg:
    v_lshlrev_b32 v4, 3, v1
    s_lshl_b32 s18, s60, 9
    s_add_u32 s18, s18, 7602176
    buffer_load_dwordx2 v[134:135], v4, s[4:7], s18 offen sc1
    s_mov_b32 s22, 5
L_dma0bg:
    s_mov_b32 m0, s63
    s_add_u32 s63, s63, 8192
    buffer_load_dwordx4 v119, s[4:7], s62 offen lds
    s_add_u32 s62, s62, 8192
    s_sub_u32 s22, s22, 1
    s_cmp_lg_u32 s22, 0
    s_cbranch_scc1 L_dma0bg
L_nomid:
    s_cmp_lg_u32 s54, 0
    s_cbranch_scc1 L_r
    s_waitcnt lgkmcnt(0)
    s_nop 7
    s_cmp_eq_u32 s53, 0
    s_cbranch_scc1 L_keep
    s_lshr_b32 s54, s49, 1
    s_cmp_lt_u32 s54, 4
    s_cselect_b32 s55, 0, 69632
    s_lshl_b32 s54, s54, 12
    s_add_u32 s54, s54, s55
    s_add_u32 s54, s54, 65536
    v_lshlrev_b32 v4, 4, v1
    v_add_u32 v4, s54, v4
    ds_write_b128 v4, v[80:83] offset:0
    ds_write_b128 v4, v[84:87] offset:1024
    ds_write_b128 v4, v[88:91] offset:2048
    ds_write_b128 v4, v[92:95] offset:3072
    s_branch L_next
L_keep:
    s_cmp_eq_u32 s51, 0
    s_cbranch_scc0 L_next
    v_mov_b32 v96, v80
    v_mov_b32 v97, v81
    v_mov_b32 v98, v82
    v_mov_b32 v99, v83
    v_mov_b32 v100, v84
    v_mov_b32 v101, v85
    v_mov_b32 v102, v86
    v_mov_b32 v103, v87
    v_mov_b32 v104, v88
    v_mov_b32 v105, v89
    v_mov_b32 v106, v90
    v_mov_b32 v107, v91
    v_mov_b32 v108, v92
    v_mov_b32 v109, v93
    v_mov_b32 v110, v94
    v_mov_b32 v111, v95
L_next:
    s_add_u32 s49, s49, 8
    s_add_u32 s51, s51, 1
    s_cmp_lt_u32 s49, s50
    s_cbranch_scc1 L_unit
    s_waitcnt lgkmcnt(0)
    s_cmp_eq_u32 s32, 1
    s_cbranch_scc0 L_nomid2
    s_lshr_b32 s14, s60, 3
    s_lshl_b32 s14, s14, 8
    s_bfe_u32 s15, s2, 0x20003
    s_lshl_b32 s15, s15, 10
    s_add_u32 s14, s14, s15
    s_add_u32 s14, s14, 15376384
    s_cmp_eq_u32 s10, 7
    s_cbranch_scc0 L_poll6_e
    v_lshlrev_b32 v2, 2, v1
    v_cmp_lt_u32 vcc, 6, v1
    v_add_u32 v2, 64, v2
    v_add_u32 v3, 36, v2
    v_cndmask_b32 v2, v2, v3, vcc
    s_lshl_b32 s15, s61, 3
    s_sub_u32 s15, s15, 56
    v_lshlrev_b32 v3, 2, v1
    v_cmp_lt_u32 vcc, 13, v1
    v_add_u32 v3, s15, v3
    s_nop 0
    v_cndmask_b32 v2, v2, v3, vcc
    s_mov_b64 s[40:41], exec
    s_mov_b32 exec_lo, 0xffff
    s_mov_b32 exec_hi, 0
    s_mov_b32 s42, 20000
L_poll6:
    buffer_load_dword v4, v2, s[4:7], s14 offen sc1
    s_waitcnt vmcnt(0)
    v_cmp_ne_u32 vcc, s3, v4
    s_nop 3
    s_cmp_eq_u64 vcc, 0
    s_cbranch_scc1 L_poll6_d
    s_sub_u32 s42, s42, 1
    s_cmp_lg_u32 s42, 0
    s_cbranch_scc1 L_poll6
L_poll6_d:
    s_mov_b64 exec, s[40:41]
L_poll6_e:
    s_barrier
    v_lshlrev_b32 v119, 4, v1
    s_lshl_b32 s15, s61, 3
    s_add_u32 s15, s15, s10
    s_mul_i32 s16, s60, 73728
    s_mul_i32 s17, s15, 1152
    s_add_u32 s16, s16, s17
    s_add_u32 s16, s16, 5242880
    s_add_u32 s17, s16, 1024
    v_and_b32 v2, 31, v1
    v_lshlrev_b32 v2, 2, v2
    s_mul_i32 s62, s60, 155648
    s_lshl_b32 s63, s10, 10
    s_add_u32 s62, s62, s63
    s_mov_b32 s22, 3
L_dma0ax:
    s_mov_b32 m0, s63
    s_add_u32 s63, s63, 8192
    buffer_load_dwordx4 v119, s[4:7], s62 offen lds
    s_add_u32 s62, s62, 8192
    s_sub_u32 s22, s22, 1
    s_cmp_lg_u32 s22, 0
    s_cbranch_scc1 L_dma0ax
    buffer_load_dwordx4 v[112:115], v119, s[4:7], s16 offen
    buffer_load_dword v116, v2, s[4:7], s17 offen
    s_cmp_eq_u32 s10, 7
    s_cbranch_scc0 L_m2ex
    s_lshr_b32 s14, s60, 3
    s_lshl_b32 s14, s14, 8
    s_bfe_u32 s15, s2, 0x20003
    s_lshl_b32 s15, s15, 10
    s_add_u32 s14, s14, s15
    s_add_u32 s14, s14, 15376384
    v_lshlrev_b32 v2, 2, v1
    v_min_u32 v2, 188, v2
    buffer_load_dword v136, v2, s[4:7], s14 offen sc1
L_m2ex:
    v_lshlrev_b32 v4, 3, v1
    s_lshl_b32 s18, s60, 9
    s_add_u32 s18, s18, 7602176
    buffer_load_dwordx2 v[134:135], v4, s[4:7], s18 offen sc1
    s_mov_b32 s22, 5
L_dma0bx:
    s_mov_b32 m0, s63
    s_add_u32 s63, s63, 8192
    buffer_load_dwordx4 v119, s[4:7], s62 offen lds
    s_add_u32 s62, s62, 8192
    s_sub_u32 s22, s22, 1
    s_cmp_lg_u32 s22, 0
    s_cbranch_scc1 L_dma0bx
L_nomid2:
    s_barrier
    s_waitcnt vmcnt(5)
    s_mov_b32 s27, 20000
L_nrm_chk:
    v_cmp_ne_u32 vcc, s3, v135
    s_nop 3
    s_cmp_eq_u64 vcc, 0
    s_cbranch_scc1 L_nrm_ok
    s_sub_u32 s27, s27, 1
    s_cmp_eq_u32 s27, 0
    s_cbranch_scc1 L_nrm_ok
    v_lshlrev_b32 v4, 3, v1
    s_lshl_b32 s18, s60, 9
    s_add_u32 s18, s18, 7602176
    buffer_load_dwordx2 v[134:135], v4, s[4:7], s18 offen sc1
    s_waitcnt vmcnt(0)
    s_branch L_nrm_chk
L_nrm_ok:
    v_cmp_gt_u32 vcc, 32, v1
    s_nop 1
    v_max_f32_dpp v134, v134, v134 row_ror:8 row_mask:0xf bank_mask:0xf
    s_nop 1
    v_max_f32_dpp v134, v134, v134 row_ror:4 row_mask:0xf bank_mask:0xf
    s_nop 1
    v_max_f32_dpp v134, v134, v134 row_ror:2 row_mask:0xf bank_mask:0xf
    s_nop 1
    v_max_f32_dpp v134, v134, v134 row_ror:1 row_mask:0xf bank_mask:0xf
    v_cndmask_b32 v116, 0, v116, vcc
    v_mov_b32 v4, 0
    v_readlane_b32 s26, v134, 0
    v_readlane_b32 s27, v134, 16
    v_readlane_b32 s28, v134, 32
    v_readlane_b32 s29, v134, 48
    v_dot2_f32_bf16 v4, v112, v112, v4
    v_dot2_f32_bf16 v4, v113, v113, v4
    v_dot2_f32_bf16 v4, v114, v114, v4
    v_dot2_f32_bf16 v4, v115, v115, v4
    v_dot2_f32_bf16 v4, v116, v116, v4
    s_max_u32 s26, s26, s27
    s_max_u32 s28, s28, s29
    s_max_u32 s26, s26, s28
    s_nop 0
    v_mov_b32 v5, v4
    s_nop 1
    v_permlane32_swap_b32 v4, v5
    s_nop 1
    v_add_f32 v4, v4, v5
    v_mul_f32 v3, s26, v4
    v_sqrt_f32 v3, v3
    v_mov_b32 v5, 1109393408
    v_cmp_nle_f32 s[30:31], v3, v5
    v_add_u32 v3, 0x1ffff, v3
    v_lshrrev_b32 v3, 16, v3
    v_or_b32 v3, 0x8000, v3
    v_cndmask_b32 v117, 0, v3, vcc
    s_cmp_lg_u64 s[30:31], 0
    s_cselect_b32 s30, 1, 0
    v_mov_b32 v3, s30
    s_lshl_b32 s31, s10, 2
    v_mov_b32 v4, s31
    v_add_u32 v4, 163584, v4
    ds_write_b32 v4, v3
    v_mov_b32 v3, 0
    ds_write_b32 v4, v3 offset:64
    s_bitcmp1_b32 s10, 0
    s_cbranch_scc1 L_cdone
    s_mov_b32 s49, s10
    s_lshr_b32 s54, s49, 1
    s_cmp_lt_u32 s54, 4
    s_cselect_b32 s55, 0, 69632
    s_lshl_b32 s54, s54, 12
    s_add_u32 s54, s54, s55
    s_add_u32 s54, s54, 65536
    v_lshlrev_b32 v4, 4, v1
    v_add_u32 v4, s54, v4
    ds_read_b128 v[16:19], v4 offset:0
    ds_read_b128 v[20:23], v4 offset:1024
    ds_read_b128 v[24:27], v4 offset:2048
    ds_read_b128 v[28:31], v4 offset:3072
    s_waitcnt lgkmcnt(0)
    v_add_f32 v16, v16, v96
    v_add_f32 v17, v17, v97
    v_add_f32 v18, v18, v98
    v_add_f32 v19, v19, v99
    v_cvt_pk_bf16_f32 v232, v16, v17
    v_cvt_pk_bf16_f32 v233, v18, v19
    v_add_f32 v20, v20, v100
    v_add_f32 v21, v21, v101
    v_add_f32 v22, v22, v102
    v_add_f32 v23, v23, v103
    v_cvt_pk_bf16_f32 v234, v20, v21
    v_cvt_pk_bf16_f32 v235, v22, v23
    v_add_f32 v24, v24, v104
    v_add_f32 v25, v25, v105
    v_add_f32 v26, v26, v106
    v_add_f32 v27, v27, v107
    v_cvt_pk_bf16_f32 v236, v24, v25
    v_cvt_pk_bf16_f32 v237, v26, v27
    v_add_f32 v28, v28, v108
    v_add_f32 v29, v29, v109
    v_add_f32 v30, v30, v110
    v_add_f32 v31, v31, v111
    v_cvt_pk_bf16_f32 v238, v28, v29
    v_cvt_pk_bf16_f32 v239, v30, v31
    s_add_u32 s49, s49, 8
    s_cmp_lt_u32 s49, s50
    s_cbranch_scc0 L_cdone
    s_lshr_b32 s54, s49, 1
    s_cmp_lt_u32 s54, 4
    s_cselect_b32 s55, 0, 69632
    s_lshl_b32 s54, s54, 12
    s_add_u32 s54, s54, s55
    s_add_u32 s54, s54, 65536
    v_lshlrev_b32 v4, 4, v1
    v_add_u32 v4, s54, v4
    ds_read_b128 v[16:19], v4 offset:0
    ds_read_b128 v[20:23], v4 offset:1024
    ds_read_b128 v[24:27], v4 offset:2048
    ds_read_b128 v[28:31], v4 offset:3072
    s_waitcnt lgkmcnt(0)
    v_add_f32 v16, v16, v80
    v_add_f32 v17, v17, v81
    v_add_f32 v18, v18, v82
    v_add_f32 v19, v19, v83
    v_cvt_pk_bf16_f32 v240, v16, v17
    v_cvt_pk_bf16_f32 v241, v18, v19
    v_add_f32 v20, v20, v84
    v_add_f32 v21, v21, v85
    v_add_f32 v22, v22, v86
    v_add_f32 v23, v23, v87
    v_cvt_pk_bf16_f32 v242, v20, v21
    v_cvt_pk_bf16_f32 v243, v22, v23
    v_add_f32 v24, v24, v88
    v_add_f32 v25, v25, v89
    v_add_f32 v26, v26, v90
    v_add_f32 v27, v27, v91
    v_cvt_pk_bf16_f32 v244, v24, v25
    v_cvt_pk_bf16_f32 v245, v26, v27
    v_add_f32 v28, v28, v92
    v_add_f32 v29, v29, v93
    v_add_f32 v30, v30, v94
    v_add_f32 v31, v31, v95
    v_cvt_pk_bf16_f32 v246, v28, v29
    v_cvt_pk_bf16_f32 v247, v30, v31
L_cdone:
    s_waitcnt vmcnt(0)
    s_cmp_eq_u32 s10, 7
    s_cbranch_scc0 L_f1c_e
    v_cmp_ne_u32 vcc, s3, v136
    s_nop 3
    s_cmp_eq_u64 vcc, 0
    s_cbranch_scc1 L_f1c_e
    s_lshr_b32 s14, s60, 3
    s_lshl_b32 s14, s14, 8
    s_bfe_u32 s15, s2, 0x20003
    s_lshl_b32 s15, s15, 10
    s_add_u32 s14, s14, s15
    s_add_u32 s14, s14, 15376384
    v_lshlrev_b32 v2, 2, v1
    s_mov_b64 s[40:41], exec
    s_mov_b32 exec_lo, -1
    s_mov_b32 exec_hi, 0xffff
    s_mov_b32 s42, 20000
L_poll7:
    buffer_load_dword v4, v2, s[4:7], s14 offen sc1
    s_waitcnt vmcnt(0)
    v_cmp_ne_u32 vcc, s3, v4
    s_nop 3
    s_cmp_eq_u64 vcc, 0
    s_cbranch_scc1 L_poll7_d
    s_sub_u32 s42, s42, 1
    s_cmp_lg_u32 s42, 0
    s_cbranch_scc1 L_poll7
L_poll7_d:
    s_mov_b64 exec, s[40:41]
L_poll7_e:
L_f1c_e:
    s_waitcnt lgkmcnt(0)
    s_barrier
    s_bitcmp1_b32 s10, 0
    s_cbranch_scc1 L_ysdone
    s_mov_b32 s49, s10
    s_lshl_b32 s50, s35, 2
    v_and_b32 v2, 15, v1
    v_lshrrev_b32 v3, 4, v1
    v_lshlrev_b32 v2, 6, v2
    v_lshl_add_u32 v2, v3, 3, v2
    s_lshr_b32 s39, s49, 2
    s_add_u32 s40, s34, s39
    s_lshl_b32 s40, s40, 12
    s_bfe_u32 s52, s49, 0x10001
    s_lshl_b32 s52, s52, 5
    s_add_u32 s40, s40, s52
    s_add_u32 s40, s40, 9986048
    buffer_store_dwordx2 v[232:233], v2, s[4:7], s40 offen offset:0 sc1
    buffer_store_dwordx2 v[234:235], v2, s[4:7], s40 offen offset:1024 sc1
    buffer_store_dwordx2 v[236:237], v2, s[4:7], s40 offen offset:2048 sc1
    buffer_store_dwordx2 v[238:239], v2, s[4:7], s40 offen offset:3072 sc1
    s_add_u32 s49, s49, 8
    s_cmp_lt_u32 s49, s50
    s_cbranch_scc0 L_ysdone
    s_lshr_b32 s39, s49, 2
    s_add_u32 s40, s34, s39
    s_lshl_b32 s40, s40, 12
    s_bfe_u32 s52, s49, 0x10001
    s_lshl_b32 s52, s52, 5
    s_add_u32 s40, s40, s52
    s_add_u32 s40, s40, 9986048
    buffer_store_dwordx2 v[240:241], v2, s[4:7], s40 offen offset:0 sc1
    buffer_store_dwordx2 v[242:243], v2, s[4:7], s40 offen offset:1024 sc1
    buffer_store_dwordx2 v[244:245], v2, s[4:7], s40 offen offset:2048 sc1
    buffer_store_dwordx2 v[246:247], v2, s[4:7], s40 offen offset:3072 sc1
L_ysdone:
    v_mov_b32 v4, 163584
    ds_read_b128 v[48:51], v4
    ds_read_b128 v[52:55], v4 offset:16
    v_lshlrev_b32 v119, 4, v1
    v_lshlrev_b32 v23, 4, v1
    v_and_b32 v2, 31, v1
    v_lshlrev_b32 v24, 2, v2
    v_add_u32 v24, 1024, v24
    v_cmp_gt_u32 vcc, 32, v1
    v_mov_b32 v5, 1456
    s_nop 0
    v_cndmask_b32 v24, v5, v24, vcc
    ds_read_b128 v[16:19], v23 offset:0
    ds_read_b32 v20, v24
    v_mov_b32 v22, 0xdddddddd
    v_mov_b32 v21, 0x3f803f80
    v_lshrrev_b32 v25, 5, v1
    v_mul_u32_u24 v25, 320, v25
    v_min_u32 v2, 19, v2
    v_lshlrev_b32 v2, 4, v2
    v_add3_u32 v25, v25, v2, 0
    v_add_u32 v25, 1152, v25
    v_mov_b32 v80, 0
    v_mov_b32 v81, 0
    v_mov_b32 v82, 0
    v_mov_b32 v83, 0
    v_mov_b32 v84, 0
    v_mov_b32 v85, 0
    v_mov_b32 v86, 0
    v_mov_b32 v87, 0
    v_mov_b32 v88, 0
    v_mov_b32 v89, 0
    v_mov_b32 v90, 0
    v_mov_b32 v91, 0
    v_mov_b32 v92, 0
    v_mov_b32 v93, 0
    v_mov_b32 v94, 0
    v_mov_b32 v95, 0
    v_mov_b32 v72, 0
    v_mov_b32 v73, 0
    v_mov_b32 v74, 0
    v_mov_b32 v75, 0
    v_mov_b32 v76, 0
    v_mov_b32 v77, 0
    v_mov_b32 v78, 0
    v_mov_b32 v79, 0
    v_mov_b32 v40, 0
    v_mov_b32 v41, 0
    v_mov_b32 v42, 0
    v_mov_b32 v43, 0
    s_waitcnt lgkmcnt(0)
    v_or3_b32 v48, v48, v49, v50
    v_or3_b32 v51, v51, v52, v53
    v_or3_b32 v48, v48, v54, v55
    v_or_b32 v48, v48, v51
    s_nop 0
    v_readfirstlane_b32 s30, v48
    s_cmp_lg_u32 s30, 0
    s_cbranch_scc1 L_fb
L_fbret:
    v_mfma_f32_32x32x16_bf16 v[48:63], v[16:19], v[112:115], 0
    s_nop 9
    v_mfma_f32_32x32x8bf16_1k v[48:63], v[20:21], v[116:117], v[48:63]
    ds_read_b128 v[16:19], v23 offset:2432
    ds_read_b32 v20, v24 offset:2432
    ds_read_b128 v[28:31], v25
    ds_read_b128 v[32:35], v25 offset:640
    s_nop 7
    s_setprio 1
    s_mov_b32 s23, 0
L_loop:
    s_cmp_lt_u32 s10, 4
    s_cselect_b32 s25, 3, 5
    s_cmp_ge_u32 s10, 4
    s_cbranch_scc1 L_p2_None
    s_setprio 2
L_p2_None:
    v_exp_f32 v48, v48
    v_exp_f32 v49, v49
    v_exp_f32 v50, v50
    v_exp_f32 v51, v51
    v_smfmac_f32_32x32x32_bf16 v[80:95], v[40:43], v[72:79], v22
    v_exp_f32 v52, v52
    v_exp_f32 v53, v53
    v_exp_f32 v54, v54
    v_exp_f32 v55, v55
    s_waitcnt lgkmcnt(0)
    v_mfma_f32_32x32x16_bf16 v[64:79], v[16:19], v[112:115], 0
    v_exp_f32 v56, v56
    v_exp_f32 v57, v57
    v_exp_f32 v58, v58
    v_exp_f32 v59, v59
    v_mfma_f32_32x32x8bf16_1k v[64:79], v[20:21], v[116:117], v[64:79]
    s_bitcmp1_b32 1, s23
    s_cbranch_scc1 L_hk0
L_hr0:
    ds_read_b128 v[16:19], v23 offset:4864
    ds_read_b32 v20, v24 offset:4864
    ds_read_b128 v[36:39], v25 offset:2432
    ds_read_b128 v[40:43], v25 offset:3072
    v_exp_f32 v60, v60
    v_exp_f32 v61, v61
    v_exp_f32 v62, v62
    v_exp_f32 v63, v63
    v_smfmac_f32_32x32x32_bf16 v[80:95], v[28:31], v[48:55], v22
    v_exp_f32 v64, v64
    v_exp_f32 v65, v65
    v_exp_f32 v66, v66
    v_exp_f32 v67, v67
    v_smfmac_f32_32x32x32_bf16 v[80:95], v[32:35], v[56:63], v22
    v_exp_f32 v68, v68
    v_exp_f32 v69, v69
    v_exp_f32 v70, v70
    v_exp_f32 v71, v71
    s_waitcnt lgkmcnt(0)
    v_mfma_f32_32x32x16_bf16 v[48:63], v[16:19], v[112:115], 0
    v_exp_f32 v72, v72
    v_exp_f32 v73, v73
    v_exp_f32 v74, v74
    v_exp_f32 v75, v75
    v_mfma_f32_32x32x8bf16_1k v[48:63], v[20:21], v[116:117], v[48:63]
    s_cmp_eq_u32 s23, s25
    s_cbranch_scc1 L_hk1
L_hr1:
    ds_read_b128 v[16:19], v23 offset:7296
    ds_read_b32 v20, v24 offset:7296
    ds_read_b128 v[28:31], v25 offset:4864
    ds_read_b128 v[32:35], v25 offset:5504
    v_exp_f32 v76, v76
    v_exp_f32 v77, v77
    v_exp_f32 v78, v78
    v_exp_f32 v79, v79
    v_smfmac_f32_32x32x32_bf16 v[80:95], v[36:39], v[64:71], v22
    v_exp_f32 v48, v48
    v_exp_f32 v49, v49
    v_exp_f32 v50, v50
    v_exp_f32 v51, v51
    v_smfmac_f32_32x32x32_bf16 v[80:95], v[40:43], v[72:79], v22
    v_exp_f32 v52, v52
    v_exp_f32 v53, v53
    v_exp_f32 v54, v54
    v_exp_f32 v55, v55
    s_waitcnt lgkmcnt(0)
    v_mfma_f32_32x32x16_bf16 v[64:79], v[16:19], v[112:115], 0
    v_exp_f32 v56, v56
    v_exp_f32 v57, v57
    v_exp_f32 v58, v58
    v_exp_f32 v59, v59
    v_mfma_f32_32x32x8bf16_1k v[64:79], v[20:21], v[116:117], v[64:79]
    s_bitcmp1_b32 1, s23
    s_cbranch_scc1 L_hk2
L_hr2:
    ds_read_b128 v[16:19], v23 offset:9728
    ds_read_b32 v20, v24 offset:9728
    ds_read_b128 v[36:39], v25 offset:7296
    ds_read_b128 v[40:43], v25 offset:7936
    v_exp_f32 v60, v60
    v_exp_f32 v61, v61
    v_exp_f32 v62, v62
    v_exp_f32 v63, v63
    v_smfmac_f32_32x32x32_bf16 v[80:95], v[28:31], v[48:55], v22
    v_exp_f32 v64, v64
    v_exp_f32 v65, v65
    v_exp_f32 v66, v66
    v_exp_f32 v67, v67
    v_smfmac_f32_32x32x32_bf16 v[80:95], v[32:35], v[56:63], v22
    v_exp_f32 v68, v68
    v_exp_f32 v69, v69
    v_exp_f32 v70, v70
    v_exp_f32 v71, v71
    s_waitcnt lgkmcnt(0)
    v_mfma_f32_32x32x16_bf16 v[48:63], v[16:19], v[112:115], 0
    v_exp_f32 v72, v72
    v_exp_f32 v73, v73
    v_exp_f32 v74, v74
    v_exp_f32 v75, v75
    v_mfma_f32_32x32x8bf16_1k v[48:63], v[20:21], v[116:117], v[48:63]
    s_cmp_eq_u32 s23, s25
    s_cbranch_scc1 L_hk3
L_hr3:
    ds_read_b128 v[16:19], v23 offset:12160
    ds_read_b32 v20, v24 offset:12160
    ds_read_b128 v[28:31], v25 offset:9728
    ds_read_b128 v[32:35], v25 offset:10368
    v_exp_f32 v76, v76
    v_exp_f32 v77, v77
    v_exp_f32 v78, v78
    v_exp_f32 v79, v79
    v_smfmac_f32_32x32x32_bf16 v[80:95], v[36:39], v[64:71], v22
    v_exp_f32 v48, v48
    v_exp_f32 v49, v49
    v_exp_f32 v50, v50
    v_exp_f32 v51, v51
    v_smfmac_f32_32x32x32_bf16 v[80:95], v[40:43], v[72:79], v22
    v_exp_f32 v52, v52
    v_exp_f32 v53, v53
    v_exp_f32 v54, v54
    v_exp_f32 v55, v55
    s_waitcnt lgkmcnt(0)
    v_mfma_f32_32x32x16_bf16 v[64:79], v[16:19], v[112:115], 0
    v_exp_f32 v56, v56
    v_exp_f32 v57, v57
    v_exp_f32 v58, v58
    v_exp_f32 v59, v59
    v_mfma_f32_32x32x8bf16_1k v[64:79], v[20:21], v[116:117], v[64:79]
    s_bitcmp1_b32 1, s23
    s_cbranch_scc1 L_hk4
L_hr4:
    ds_read_b128 v[16:19], v23 offset:14592
    ds_read_b32 v20, v24 offset:14592
    ds_read_b128 v[36:39], v25 offset:12160
    ds_read_b128 v[40:43], v25 offset:12800
    v_exp_f32 v60, v60
    v_exp_f32 v61, v61
    v_exp_f32 v62, v62
    v_exp_f32 v63, v63
    v_smfmac_f32_32x32x32_bf16 v[80:95], v[28:31], v[48:55], v22
    s_cmp_ge_u32 s10, 4
    s_cbranch_scc1 L_p0_85
    s_bitcmp1_b32 85, s23
    s_cbranch_scc0 L_p0_85
    s_setprio 0
L_p0_85:
    v_exp_f32 v64, v64
    v_exp_f32 v65, v65
    v_exp_f32 v66, v66
    v_exp_f32 v67, v67
    v_smfmac_f32_32x32x32_bf16 v[80:95], v[32:35], v[56:63], v22
    v_exp_f32 v68, v68
    v_exp_f32 v69, v69
    v_exp_f32 v70, v70
    v_exp_f32 v71, v71
    s_waitcnt lgkmcnt(0)
    v_mfma_f32_32x32x16_bf16 v[48:63], v[16:19], v[112:115], 0
    v_exp_f32 v72, v72
    v_exp_f32 v73, v73
    v_exp_f32 v74, v74
    v_exp_f32 v75, v75
    v_mfma_f32_32x32x8bf16_1k v[48:63], v[20:21], v[116:117], v[48:63]
    s_cmp_eq_u32 s23, s25
    s_cbranch_scc1 L_hk5
L_hr5:
    ds_read_b128 v[16:19], v23 offset:17024
    ds_read_b32 v20, v24 offset:17024
    ds_read_b128 v[28:31], v25 offset:14592
    ds_read_b128 v[32:35], v25 offset:15232
    v_exp_f32 v76, v76
    v_exp_f32 v77, v77
    v_exp_f32 v78, v78
    v_exp_f32 v79, v79
    v_smfmac_f32_32x32x32_bf16 v[80:95], v[36:39], v[64:71], v22
    s_cmp_ge_u32 s10, 4
    s_cbranch_scc1 L_p0_None
    s_setprio 0
L_p0_None:
    v_exp_f32 v48, v48
    v_exp_f32 v49, v49
    v_exp_f32 v50, v50
    v_exp_f32 v51, v51
    v_smfmac_f32_32x32x32_bf16 v[80:95], v[40:43], v[72:79], v22
    v_exp_f32 v52, v52
    v_exp_f32 v53, v53
    v_exp_f32 v54, v54
    v_exp_f32 v55, v55
    s_waitcnt lgkmcnt(0)
    v_mfma_f32_32x32x16_bf16 v[64:79], v[16:19], v[112:115], 0
    v_exp_f32 v56, v56
    v_exp_f32 v57, v57
    v_exp_f32 v58, v58
    v_exp_f32 v59, v59
    v_mfma_f32_32x32x8bf16_1k v[64:79], v[20:21], v[116:117], v[64:79]
    s_bitcmp1_b32 5, s23
    s_cbranch_scc1 L_hk6
L_hr6:
    ds_read_b128 v[16:19], v23 offset:19456
    ds_read_b32 v20, v24 offset:19456
    ds_read_b128 v[36:39], v25 offset:17024
    ds_read_b128 v[40:43], v25 offset:17664
    v_exp_f32 v60, v60
    v_exp_f32 v61, v61
    v_exp_f32 v62, v62
    v_exp_f32 v63, v63
    v_smfmac_f32_32x32x32_bf16 v[80:95], v[28:31], v[48:55], v22
    v_exp_f32 v64, v64
    v_exp_f32 v65, v65
    v_exp_f32 v66, v66
    v_exp_f32 v67, v67
    v_smfmac_f32_32x32x32_bf16 v[80:95], v[32:35], v[56:63], v22
    v_exp_f32 v68, v68
    v_exp_f32 v69, v69
    v_exp_f32 v70, v70
    v_exp_f32 v71, v71
    s_waitcnt lgkmcnt(0)
    v_mfma_f32_32x32x16_bf16 v[48:63], v[16:19], v[112:115], 0
    v_exp_f32 v72, v72
    v_exp_f32 v73, v73
    v_exp_f32 v74, v74
    v_exp_f32 v75, v75
    v_mfma_f32_32x32x8bf16_1k v[48:63], v[20:21], v[116:117], v[48:63]
    s_cmp_eq_u32 s23, 1
    s_cbranch_scc1 L_hs7
    s_cmp_eq_u32 s23, s25
    s_cbranch_scc1 L_hk7
L_hr7:
    ds_read_b128 v[16:19], v23 offset:21888
    ds_read_b32 v20, v24 offset:21888
    ds_read_b128 v[28:31], v25 offset:19456
    ds_read_b128 v[32:35], v25 offset:20096
    v_exp_f32 v76, v76
    v_exp_f32 v77, v77
    v_exp_f32 v78, v78
    v_exp_f32 v79, v79
    v_smfmac_f32_32x32x32_bf16 v[80:95], v[36:39], v[64:71], v22
    v_add_u32 v23, 19456, v23
    v_add_u32 v24, 19456, v24
    v_add_u32 v25, 19456, v25
    s_add_u32 s23, s23, 1
    s_cmp_lt_u32 s23, 8
    s_cbranch_scc1 L_loop
    s_setprio 0
    s_nop 1
    v_smfmac_f32_32x32x32_bf16 v[80:95], v[40:43], v[72:79], v22
    s_waitcnt lgkmcnt(0)
    s_nop 15
    v_mov_b32 v2, v90
    v_mov_b32 v3, v90
    s_nop 1
    v_permlane32_swap_b32 v2, v3
    s_nop 1
    v_rcp_f32 v2, v2
    s_nop 0
    v_mul_f32 v80, v80, v2
    v_mul_f32 v81, v81, v2
    v_mul_f32 v82, v82, v2
    v_mul_f32 v83, v83, v2
    v_mul_f32 v84, v84, v2
    v_mul_f32 v85, v85, v2
    v_mul_f32 v86, v86, v2
    v_mul_f32 v87, v87, v2
    v_mul_f32 v88, v88, v2
    v_mul_f32 v89, v89, v2
    v_cvt_pk_bf16_f32 v8, v80, v81
    v_cvt_pk_bf16_f32 v9, v82, v83
    v_cvt_pk_bf16_f32 v10, v84, v85
    v_cvt_pk_bf16_f32 v11, v86, v87
    v_cvt_pk_bf16_f32 v12, v88, v89
    s_nop 1
    v_permlane32_swap_b32 v8, v10
    v_permlane32_swap_b32 v9, v11
    s_lshl_b32 s15, s61, 3
    s_add_u32 s15, s15, s10
    v_and_b32 v3, 31, v1
    v_lshrrev_b32 v4, 5, v1
    v_lshlrev_b32 v5, 5, v3
    v_lshl_add_u32 v5, v4, 4, v5
    s_lshl_b32 s16, s60, 16
    s_lshl_b32 s17, s15, 10
    s_add_u32 s16, s16, s17
    s_add_u32 s16, s16, 12345344
    buffer_store_dwordx4 v[8:11], v5, s[4:7], s16 offen sc1
    v_lshlrev_b32 v5, 2, v3
    s_lshl_b32 s16, s15, 7
    s_lshl_b32 s17, s60, 13
    s_add_u32 s16, s16, s17
    s_add_u32 s16, s16, 14442496
    v_cmp_gt_u32 vcc, 32, v1
    s_and_saveexec_b64 s[24:25], vcc
    buffer_store_dword v12, v5, s[4:7], s16 offen sc1
    s_mov_b64 exec, s[24:25]
    s_waitcnt vmcnt(0)
    s_lshl_b32 s14, s61, 3
    s_add_u32 s14, s14, s10
    s_lshl_b32 s14, s14, 7
    s_lshl_b32 s15, s60, 2
    s_add_u32 s14, s14, s15
    s_add_u32 s14, s14, 15388672
    v_mov_b32 v2, s3
    v_mov_b32 v3, 0
    s_mov_b64 s[40:41], exec
    s_mov_b64 exec, 1
    buffer_store_dword v2, v3, s[4:7], s14 offen sc1
    s_mov_b64 exec, s[40:41]
    s_and_b32 s14, s2, 7
    s_lshl_b32 s14, s14, 10
    s_add_u32 s14, s14, 15380480
    s_cmp_eq_u32 s10, 6
    s_cbranch_scc0 L_poll9_e
    v_lshlrev_b32 v2, 4, v1
    s_mov_b64 s[40:41], exec
    s_mov_b32 s42, 20000
L_poll9:
    buffer_load_dwordx4 v[4:7], v2, s[4:7], s14 offen sc1
    s_waitcnt vmcnt(0)
    v_xor_b32 v4, s3, v4
    v_xor_b32 v5, s3, v5
    v_xor_b32 v6, s3, v6
    v_xor_b32 v7, s3, v7
    v_or3_b32 v4, v4, v5, v6
    v_or_b32 v4, v4, v7
    v_cmp_ne_u32 vcc, 0, v4
    s_nop 3
    s_cmp_eq_u64 vcc, 0
    s_cbranch_scc1 L_poll9_d
    s_sub_u32 s42, s42, 1
    s_cmp_lg_u32 s42, 0
    s_cbranch_scc1 L_poll9
L_poll9_d:
    s_mov_b64 exec, s[40:41]
L_poll9_e:
    s_barrier
    v_and_b32 v2, 15, v1
    v_lshrrev_b32 v3, 4, v1
    v_lshlrev_b32 v5, 14, v3
    v_and_b32 v6, 14, v2
    v_lshl_add_u32 v5, v6, 1, v5
    s_mul_i32 s33, s97, 589824
    s_lshl_b32 s34, s96, 1
    s_add_u32 s33, s33, s34
    s_add_u32 s33, s33, 9986048
    s_lshl_b32 s34, s10, 16
    s_add_u32 s34, s34, s33
    s_lshl_b32 s35, s10, 5
    s_add_u32 s35, s35, s33
    s_add_u32 s35, s35, 524288
    s_add_u32 s36, s34, 0
    buffer_load_dword v202, v5, s[4:7], s36 offen
    buffer_load_dword v206, v5, s[4:7], s36 offen offset:32
    s_add_u32 s36, s35, 0
    buffer_load_dword v210, v5, s[4:7], s36 offen
    s_add_u32 s36, s34, 4096
    buffer_load_dword v203, v5, s[4:7], s36 offen
    buffer_load_dword v207, v5, s[4:7], s36 offen offset:32
    s_add_u32 s36, s35, 4096
    buffer_load_dword v211, v5, s[4:7], s36 offen
    s_add_u32 s36, s34, 8192
    buffer_load_dword v204, v5, s[4:7], s36 offen
    buffer_load_dword v208, v5, s[4:7], s36 offen offset:32
    s_add_u32 s36, s35, 8192
    buffer_load_dword v212, v5, s[4:7], s36 offen
    s_add_u32 s36, s34, 12288
    buffer_load_dword v205, v5, s[4:7], s36 offen
    buffer_load_dword v209, v5, s[4:7], s36 offen offset:32
    s_add_u32 s36, s35, 12288
    buffer_load_dword v213, v5, s[4:7], s36 offen
    v_lshlrev_b32 v6, 2, v2
    s_lshl_b32 s36, s96, 2
    s_add_u32 s36, s36, 7618560
    buffer_load_dword v198, v6, s[4:7], s36 offen
    buffer_load_dword v199, v6, s[4:7], s36 offen offset:64
    s_cmp_lt_u32 s10, 2
    s_cbranch_scc0 L_no8
    v_lshlrev_b32 v7, 4, v1
    s_mul_i32 s14, s97, 9
    s_add_u32 s46, s14, 8
    s_lshl_b32 s46, s46, 10
    s_add_u32 s46, s46, 14704640
    buffer_load_dwordx4 v[16:19], v7, s[4:7], s46 offen
    s_add_u32 s46, s46, 36864
    buffer_load_dwordx4 v[20:23], v7, s[4:7], s46 offen
    s_add_u32 s46, s46, 36864
    buffer_load_dwordx4 v[24:27], v7, s[4:7], s46 offen
    s_add_u32 s46, s46, 36864
    buffer_load_dwordx4 v[28:31], v7, s[4:7], s46 offen
    s_add_u32 s46, s46, 36864
    buffer_load_dwordx4 v[32:35], v7, s[4:7], s46 offen
    s_add_u32 s46, s46, 36864
    buffer_load_dwordx4 v[36:39], v7, s[4:7], s46 offen
    s_add_u32 s46, s46, 36864
    buffer_load_dwordx4 v[40:43], v7, s[4:7], s46 offen
    s_add_u32 s46, s46, 36864
    buffer_load_dwordx4 v[44:47], v7, s[4:7], s46 offen
    s_add_u32 s46, s46, 36864
    buffer_load_dwordx4 v[48:51], v7, s[4:7], s46 offen
    s_add_u32 s46, s46, 36864
    buffer_load_dwordx4 v[52:55], v7, s[4:7], s46 offen
    s_add_u32 s46, s46, 36864
    buffer_load_dwordx4 v[56:59], v7, s[4:7], s46 offen
    s_add_u32 s46, s46, 36864
    buffer_load_dwordx4 v[60:63], v7, s[4:7], s46 offen
    s_add_u32 s46, s46, 36864
    buffer_load_dwordx4 v[64:67], v7, s[4:7], s46 offen
    s_add_u32 s46, s46, 36864
    buffer_load_dwordx4 v[68:71], v7, s[4:7], s46 offen
    s_add_u32 s46, s46, 36864
    buffer_load_dwordx4 v[72:75], v7, s[4:7], s46 offen
    s_add_u32 s46, s46, 36864
    buffer_load_dwordx4 v[76:79], v7, s[4:7], s46 offen
    s_add_u32 s46, s46, 36864
    buffer_load_dwordx4 v[80:83], v7, s[4:7], s46 offen
    s_add_u32 s46, s46, 36864
    buffer_load_dwordx4 v[84:87], v7, s[4:7], s46 offen
L_no8:
    s_mov_b32 s20, s84
    s_mov_b32 s21, s85
    s_mov_b32 s22, 2359296
    s_mov_b32 s23, 0x20000
    v_and_b32 v2, 15, v1
    v_lshrrev_b32 v3, 4, v1
    v_lshrrev_b32 v8, 1, v3
    v_lshlrev_b32 v8, 16, v8
    v_lshl_add_u32 v8, v2, 5, v8
    v_and_b32 v9, 1, v3
    v_lshl_add_u32 v8, v9, 4, v8
    v_lshlrev_b32 v9, 15, v3
    v_lshl_add_u32 v9, v2, 2, v9
    s_and_b32 s38, s10, 1
    s_lshl_b32 s39, s38, 4
    s_add_u32 s39, s39, s96
    s_lshl_b32 s39, s39, 5
    s_lshr_b32 s37, s10, 1
    s_lshl_b32 s37, s37, 17
    s_add_u32 s44, s37, s39
    s_add_u32 s44, s44, 12345344
    s_lshl_b32 s45, s10, 10
    s_and_b32 s38, s10, 3
    s_lshl_b32 s46, s38, 13
    s_bfe_u32 s38, s10, 0x10002
    s_lshl_b32 s38, s38, 4
    s_add_u32 s38, s38, s96
    s_lshl_b32 s38, s38, 2
    s_add_u32 s46, s46, s38
    s_add_u32 s46, s46, 14442496
    s_lshl_b32 s47, s10, 8
    s_add_u32 s47, s47, 32768
    s_mul_i32 s28, s96, 1152
    s_mul_i32 s29, s97, 288
    s_add_u32 s28, s28, s29
    s_lshl_b32 s29, s10, 5
    s_add_u32 s30, s28, s29
    s_add_u32 s31, s30, 18432
    s_mul_i32 s32, s10, 18432
    s_add_u32 s32, s32, s28
    s_add_u32 s32, s32, 256
    v_mov_b32 v104, 0
    v_mov_b32 v105, 0
    v_mov_b32 v106, 0
    v_mov_b32 v107, 0
    v_mov_b32 v108, 0
    v_mov_b32 v109, 0
    v_mov_b32 v110, 0
    v_mov_b32 v111, 0
    v_mov_b32 v112, 0
    v_mov_b32 v113, 0
    v_mov_b32 v114, 0
    v_mov_b32 v115, 0
    s_cmp_lt_u32 s10, 2
    s_cbranch_scc1 L_bt18
    s_waitcnt vmcnt(0)
    s_branch L_btgo
L_bt18:
    s_waitcnt vmcnt(18)
L_btgo:
    s_cmp_eq_u32 s10, 1
    s_cselect_b64 vcc, -1, 0
    v_cndmask_b32 v200, v198, v199, vcc
    v_and_b32 v14, 1, v2
    v_lshlrev_b32 v14, 4, v14
    v_sub_f32 v15, 1.0, v198
    v_lshlrev_b32 v5, 16, v192
    v_lshrrev_b32 v6, v14, v202
    v_lshlrev_b32 v6, 16, v6
    v_mul_f32 v5, v5, v6
    v_mul_f32 v202, v5, v15
    v_and_b32 v5, 0xffff0000, v192
    v_lshrrev_b32 v6, v14, v203
    v_lshlrev_b32 v6, 16, v6
    v_mul_f32 v5, v5, v6
    v_mul_f32 v203, v5, v15
    v_lshlrev_b32 v5, 16, v193
    v_lshrrev_b32 v6, v14, v204
    v_lshlrev_b32 v6, 16, v6
    v_mul_f32 v5, v5, v6
    v_mul_f32 v204, v5, v15
    v_and_b32 v5, 0xffff0000, v193
    v_lshrrev_b32 v6, v14, v205
    v_lshlrev_b32 v6, 16, v6
    v_mul_f32 v5, v5, v6
    v_mul_f32 v205, v5, v15
    v_sub_f32 v15, 1.0, v199
    v_lshlrev_b32 v5, 16, v194
    v_lshrrev_b32 v6, v14, v206
    v_lshlrev_b32 v6, 16, v6
    v_mul_f32 v5, v5, v6
    v_mul_f32 v206, v5, v15
    v_and_b32 v5, 0xffff0000, v194
    v_lshrrev_b32 v6, v14, v207
    v_lshlrev_b32 v6, 16, v6
    v_mul_f32 v5, v5, v6
    v_mul_f32 v207, v5, v15
    v_lshlrev_b32 v5, 16, v195
    v_lshrrev_b32 v6, v14, v208
    v_lshlrev_b32 v6, 16, v6
    v_mul_f32 v5, v5, v6
    v_mul_f32 v208, v5, v15
    v_and_b32 v5, 0xffff0000, v195
    v_lshrrev_b32 v6, v14, v209
    v_lshlrev_b32 v6, 16, v6
    v_mul_f32 v5, v5, v6
    v_mul_f32 v209, v5, v15
    v_sub_f32 v15, 1.0, v200
    v_lshlrev_b32 v5, 16, v196
    v_lshrrev_b32 v6, v14, v210
    v_lshlrev_b32 v6, 16, v6
    v_mul_f32 v5, v5, v6
    v_mul_f32 v210, v5, v15
    v_and_b32 v5, 0xffff0000, v196
    v_lshrrev_b32 v6, v14, v211
    v_lshlrev_b32 v6, 16, v6
    v_mul_f32 v5, v5, v6
    v_mul_f32 v211, v5, v15
    v_lshlrev_b32 v5, 16, v197
    v_lshrrev_b32 v6, v14, v212
    v_lshlrev_b32 v6, 16, v6
    v_mul_f32 v5, v5, v6
    v_mul_f32 v212, v5, v15
    v_and_b32 v5, 0xffff0000, v197
    v_lshrrev_b32 v6, v14, v213
    v_lshlrev_b32 v6, 16, v6
    v_mul_f32 v5, v5, v6
    v_mul_f32 v213, v5, v15
    s_lshr_b32 s14, s96, 5
    s_lshl_b32 s14, s14, 7
    s_add_u32 s14, s14, 15388672
    s_cmp_eq_u32 s10, 7
    s_cbranch_scc0 L_poll10_e
    v_lshlrev_b32 v2, 2, v1
    s_mov_b64 s[40:41], exec
    s_mov_b32 exec_lo, 0xffffffff
    s_mov_b32 exec_hi, 0
    s_mov_b32 s42, 20000
L_poll10:
    buffer_load_dword v4, v2, s[4:7], s14 offen sc1
    s_waitcnt vmcnt(0)
    v_cmp_ne_u32 vcc, s3, v4
    s_nop 3
    s_cmp_eq_u64 vcc, 0
    s_cbranch_scc1 L_poll10_d
    s_sub_u32 s42, s42, 1
    s_cmp_lg_u32 s42, 0
    s_cbranch_scc1 L_poll10
L_poll10_d:
    s_mov_b64 exec, s[40:41]
L_poll10_e:
    s_barrier
    s_add_u32 m0, s45, 0
    s_add_u32 s36, s44, 0
    buffer_load_dwordx4 v8, s[4:7], s36 offen lds
    s_add_u32 m0, s45, 8192
    s_add_u32 s36, s44, 524288
    buffer_load_dwordx4 v8, s[4:7], s36 offen lds
    s_add_u32 m0, s45, 16384
    s_add_u32 s36, s44, 1048576
    buffer_load_dwordx4 v8, s[4:7], s36 offen lds
    s_add_u32 m0, s45, 24576
    s_add_u32 s36, s44, 1572864
    buffer_load_dwordx4 v8, s[4:7], s36 offen lds
    s_add_u32 m0, s47, 0
    s_add_u32 s36, s46, 0
    buffer_load_dword v9, s[4:7], s36 offen lds
    s_add_u32 m0, s47, 2048
    s_add_u32 s36, s46, 131072
    buffer_load_dword v9, s[4:7], s36 offen lds
    v_and_b32 v2, 15, v1
    v_lshrrev_b32 v3, 4, v1
    v_lshlrev_b32 v7, 4, v1
    s_lshl_b32 s36, s10, 10
    v_add_u32 v11, s36, v7
    v_lshlrev_b32 v12, 2, v1
    v_add_u32 v13, s36, v12
    s_waitcnt vmcnt(0)
    s_barrier
    s_cmp_lt_u32 s10, 2
    s_cbranch_scc1 L_o3
    ds_read_b128 v[88:91], v7 offset:0
    ds_read_b128 v[92:95], v7 offset:1024
    ds_read_b128 v[96:99], v7 offset:2048
    ds_read_b128 v[100:103], v7 offset:3072
    ds_read_b128 v[224:227], v7 offset:4096
    ds_read_b128 v[228:231], v7 offset:5120
    ds_read_b128 v[232:235], v7 offset:6144
    ds_read_b128 v[236:239], v7 offset:7168
    s_waitcnt lgkmcnt(6)
    v_mfma_f32_16x16x32_bf16 v[104:107], v[120:123], v[88:91], v[104:107]
    v_mfma_f32_16x16x32_bf16 v[108:111], v[120:123], v[92:95], v[108:111]
    ds_read_b128 v[88:91], v7 offset:8192
    ds_read_b128 v[92:95], v7 offset:9216
    s_waitcnt lgkmcnt(6)
    v_mfma_f32_16x16x32_bf16 v[104:107], v[124:127], v[96:99], v[104:107]
    v_mfma_f32_16x16x32_bf16 v[108:111], v[124:127], v[100:103], v[108:111]
    ds_read_b128 v[96:99], v7 offset:10240
    ds_read_b128 v[100:103], v7 offset:11264
    s_waitcnt lgkmcnt(6)
    v_mfma_f32_16x16x32_bf16 v[104:107], v[128:131], v[224:227], v[104:107]
    v_mfma_f32_16x16x32_bf16 v[108:111], v[128:131], v[228:231], v[108:111]
    ds_read_b128 v[224:227], v7 offset:12288
    ds_read_b128 v[228:231], v7 offset:13312
    s_waitcnt lgkmcnt(6)
    v_mfma_f32_16x16x32_bf16 v[104:107], v[132:135], v[232:235], v[104:107]
    v_mfma_f32_16x16x32_bf16 v[108:111], v[132:135], v[236:239], v[108:111]
    ds_read_b128 v[232:235], v7 offset:14336
    ds_read_b128 v[236:239], v7 offset:15360
    s_waitcnt lgkmcnt(6)
    v_mfma_f32_16x16x32_bf16 v[104:107], v[136:139], v[88:91], v[104:107]
    v_mfma_f32_16x16x32_bf16 v[108:111], v[136:139], v[92:95], v[108:111]
    ds_read_b128 v[88:91], v7 offset:16384
    ds_read_b128 v[92:95], v7 offset:17408
    s_waitcnt lgkmcnt(6)
    v_mfma_f32_16x16x32_bf16 v[104:107], v[140:143], v[96:99], v[104:107]
    v_mfma_f32_16x16x32_bf16 v[108:111], v[140:143], v[100:103], v[108:111]
    ds_read_b128 v[96:99], v7 offset:18432
    ds_read_b128 v[100:103], v7 offset:19456
    s_waitcnt lgkmcnt(6)
    v_mfma_f32_16x16x32_bf16 v[104:107], v[144:147], v[224:227], v[104:107]
    v_mfma_f32_16x16x32_bf16 v[108:111], v[144:147], v[228:231], v[108:111]
    ds_read_b128 v[224:227], v7 offset:20480
    ds_read_b128 v[228:231], v7 offset:21504
    s_waitcnt lgkmcnt(6)
    v_mfma_f32_16x16x32_bf16 v[104:107], v[148:151], v[232:235], v[104:107]
    v_mfma_f32_16x16x32_bf16 v[108:111], v[148:151], v[236:239], v[108:111]
    ds_read_b128 v[232:235], v7 offset:22528
    ds_read_b128 v[236:239], v7 offset:23552
    s_waitcnt lgkmcnt(6)
    v_mfma_f32_16x16x32_bf16 v[104:107], v[152:155], v[88:91], v[104:107]
    v_mfma_f32_16x16x32_bf16 v[108:111], v[152:155], v[92:95], v[108:111]
    ds_read_b128 v[88:91], v7 offset:24576
    ds_read_b128 v[92:95], v7 offset:25600
    s_waitcnt lgkmcnt(6)
    v_mfma_f32_16x16x32_bf16 v[104:107], v[156:159], v[96:99], v[104:107]
    v_mfma_f32_16x16x32_bf16 v[108:111], v[156:159], v[100:103], v[108:111]
    ds_read_b128 v[96:99], v7 offset:26624
    ds_read_b128 v[100:103], v7 offset:27648
    s_waitcnt lgkmcnt(6)
    v_mfma_f32_16x16x32_bf16 v[104:107], v[160:163], v[224:227], v[104:107]
    v_mfma_f32_16x16x32_bf16 v[108:111], v[160:163], v[228:231], v[108:111]
    ds_read_b128 v[224:227], v7 offset:28672
    ds_read_b128 v[228:231], v7 offset:29696
    s_waitcnt lgkmcnt(6)
    v_mfma_f32_16x16x32_bf16 v[104:107], v[164:167], v[232:235], v[104:107]
    v_mfma_f32_16x16x32_bf16 v[108:111], v[164:167], v[236:239], v[108:111]
    ds_read_b128 v[232:235], v7 offset:30720
    ds_read_b128 v[236:239], v7 offset:31744
    s_waitcnt lgkmcnt(6)
    v_mfma_f32_16x16x32_bf16 v[104:107], v[168:171], v[88:91], v[104:107]
    v_mfma_f32_16x16x32_bf16 v[108:111], v[168:171], v[92:95], v[108:111]
    ds_read_b32 v88, v12 offset:32768
    ds_read_b32 v89, v12 offset:33024
    ds_read_b32 v90, v12 offset:33280
    ds_read_b32 v91, v12 offset:33536
    ds_read_b32 v92, v12 offset:33792
    ds_read_b32 v93, v12 offset:34048
    ds_read_b32 v94, v12 offset:34304
    ds_read_b32 v95, v12 offset:34560
    s_waitcnt lgkmcnt(12)
    v_mfma_f32_16x16x32_bf16 v[104:107], v[172:175], v[96:99], v[104:107]
    v_mfma_f32_16x16x32_bf16 v[108:111], v[172:175], v[100:103], v[108:111]
    ds_read_b32 v96, v12 offset:34816
    ds_read_b32 v97, v12 offset:35072
    ds_read_b32 v98, v12 offset:35328
    ds_read_b32 v99, v12 offset:35584
    ds_read_b32 v100, v12 offset:35840
    ds_read_b32 v101, v12 offset:36096
    ds_read_b32 v102, v12 offset:36352
    ds_read_b32 v103, v12 offset:36608
    s_waitcnt lgkmcnt(15)
    v_mfma_f32_16x16x32_bf16 v[104:107], v[176:179], v[224:227], v[104:107]
    v_mfma_f32_16x16x32_bf16 v[108:111], v[176:179], v[228:231], v[108:111]
    s_waitcnt lgkmcnt(15)
    v_mfma_f32_16x16x32_bf16 v[104:107], v[180:183], v[232:235], v[104:107]
    v_mfma_f32_16x16x32_bf16 v[108:111], v[180:183], v[236:239], v[108:111]
    s_waitcnt lgkmcnt(8)
    v_mfma_f32_16x16x32_bf16 v[104:107], v[184:187], v[88:91], v[104:107]
    v_mfma_f32_16x16x32_bf16 v[108:111], v[184:187], v[92:95], v[108:111]
    s_waitcnt lgkmcnt(0)
    v_mfma_f32_16x16x32_bf16 v[104:107], v[188:191], v[96:99], v[104:107]
    v_mfma_f32_16x16x32_bf16 v[108:111], v[188:191], v[100:103], v[108:111]
    s_branch L_odonemm
L_o3:
    ds_read_b128 v[88:91], v7 offset:0
    ds_read_b128 v[92:95], v7 offset:1024
    ds_read_b128 v[216:219], v11 offset:0
    ds_read_b128 v[96:99], v7 offset:2048
    ds_read_b128 v[100:103], v7 offset:3072
    ds_read_b128 v[220:223], v11 offset:2048
    ds_read_b128 v[224:227], v7 offset:4096
    ds_read_b128 v[228:231], v7 offset:5120
    ds_read_b128 v[240:243], v11 offset:4096
    ds_read_b128 v[232:235], v7 offset:6144
    ds_read_b128 v[236:239], v7 offset:7168
    ds_read_b128 v[244:247], v11 offset:6144
    s_waitcnt lgkmcnt(9)
    v_mfma_f32_16x16x32_bf16 v[104:107], v[120:123], v[88:91], v[104:107]
    v_mfma_f32_16x16x32_bf16 v[108:111], v[120:123], v[92:95], v[108:111]
    v_mfma_f32_16x16x32_bf16 v[112:115], v[16:19], v[216:219], v[112:115]
    ds_read_b128 v[88:91], v7 offset:8192
    ds_read_b128 v[92:95], v7 offset:9216
    ds_read_b128 v[216:219], v11 offset:8192
    s_waitcnt lgkmcnt(9)
    v_mfma_f32_16x16x32_bf16 v[104:107], v[124:127], v[96:99], v[104:107]
    v_mfma_f32_16x16x32_bf16 v[108:111], v[124:127], v[100:103], v[108:111]
    v_mfma_f32_16x16x32_bf16 v[112:115], v[20:23], v[220:223], v[112:115]
    ds_read_b128 v[96:99], v7 offset:10240
    ds_read_b128 v[100:103], v7 offset:11264
    ds_read_b128 v[220:223], v11 offset:10240
    s_waitcnt lgkmcnt(9)
    v_mfma_f32_16x16x32_bf16 v[104:107], v[128:131], v[224:227], v[104:107]
    v_mfma_f32_16x16x32_bf16 v[108:111], v[128:131], v[228:231], v[108:111]
    v_mfma_f32_16x16x32_bf16 v[112:115], v[24:27], v[240:243], v[112:115]
    ds_read_b128 v[224:227], v7 offset:12288
    ds_read_b128 v[228:231], v7 offset:13312
    ds_read_b128 v[240:243], v11 offset:12288
    s_waitcnt lgkmcnt(9)
    v_mfma_f32_16x16x32_bf16 v[104:107], v[132:135], v[232:235], v[104:107]
    v_mfma_f32_16x16x32_bf16 v[108:111], v[132:135], v[236:239], v[108:111]
    v_mfma_f32_16x16x32_bf16 v[112:115], v[28:31], v[244:247], v[112:115]
    ds_read_b128 v[232:235], v7 offset:14336
    ds_read_b128 v[236:239], v7 offset:15360
    ds_read_b128 v[244:247], v11 offset:14336
    s_waitcnt lgkmcnt(9)
    v_mfma_f32_16x16x32_bf16 v[104:107], v[136:139], v[88:91], v[104:107]
    v_mfma_f32_16x16x32_bf16 v[108:111], v[136:139], v[92:95], v[108:111]
    v_mfma_f32_16x16x32_bf16 v[112:115], v[32:35], v[216:219], v[112:115]
    ds_read_b128 v[88:91], v7 offset:16384
    ds_read_b128 v[92:95], v7 offset:17408
    ds_read_b128 v[216:219], v11 offset:16384
    s_waitcnt lgkmcnt(9)
    v_mfma_f32_16x16x32_bf16 v[104:107], v[140:143], v[96:99], v[104:107]
    v_mfma_f32_16x16x32_bf16 v[108:111], v[140:143], v[100:103], v[108:111]
    v_mfma_f32_16x16x32_bf16 v[112:115], v[36:39], v[220:223], v[112:115]
    ds_read_b128 v[96:99], v7 offset:18432
    ds_read_b128 v[100:103], v7 offset:19456
    ds_read_b128 v[220:223], v11 offset:18432
    s_waitcnt lgkmcnt(9)
    v_mfma_f32_16x16x32_bf16 v[104:107], v[144:147], v[224:227], v[104:107]
    v_mfma_f32_16x16x32_bf16 v[108:111], v[144:147], v[228:231], v[108:111]
    v_mfma_f32_16x16x32_bf16 v[112:115], v[40:43], v[240:243], v[112:115]
    ds_read_b128 v[224:227], v7 offset:20480
    ds_read_b128 v[228:231], v7 offset:21504
    ds_read_b128 v[240:243], v11 offset:20480
    s_waitcnt lgkmcnt(9)
    v_mfma_f32_16x16x32_bf16 v[104:107], v[148:151], v[232:235], v[104:107]
    v_mfma_f32_16x16x32_bf16 v[108:111], v[148:151], v[236:239], v[108:111]
    v_mfma_f32_16x16x32_bf16 v[112:115], v[44:47], v[244:247], v[112:115]
    ds_read_b128 v[232:235], v7 offset:22528
    ds_read_b128 v[236:239], v7 offset:23552
    ds_read_b128 v[244:247], v11 offset:22528
    s_waitcnt lgkmcnt(9)
    v_mfma_f32_16x16x32_bf16 v[104:107], v[152:155], v[88:91], v[104:107]
    v_mfma_f32_16x16x32_bf16 v[108:111], v[152:155], v[92:95], v[108:111]
    v_mfma_f32_16x16x32_bf16 v[112:115], v[48:51], v[216:219], v[112:115]
    ds_read_b128 v[88:91], v7 offset:24576
    ds_read_b128 v[92:95], v7 offset:25600
    ds_read_b128 v[216:219], v11 offset:24576
    s_waitcnt lgkmcnt(9)
    v_mfma_f32_16x16x32_bf16 v[104:107], v[156:159], v[96:99], v[104:107]
    v_mfma_f32_16x16x32_bf16 v[108:111], v[156:159], v[100:103], v[108:111]
    v_mfma_f32_16x16x32_bf16 v[112:115], v[52:55], v[220:223], v[112:115]
    ds_read_b128 v[96:99], v7 offset:26624
    ds_read_b128 v[100:103], v7 offset:27648
    ds_read_b128 v[220:223], v11 offset:26624
    s_waitcnt lgkmcnt(9)
    v_mfma_f32_16x16x32_bf16 v[104:107], v[160:163], v[224:227], v[104:107]
    v_mfma_f32_16x16x32_bf16 v[108:111], v[160:163], v[228:231], v[108:111]
    v_mfma_f32_16x16x32_bf16 v[112:115], v[56:59], v[240:243], v[112:115]
    ds_read_b128 v[224:227], v7 offset:28672
    ds_read_b128 v[228:231], v7 offset:29696
    ds_read_b128 v[240:243], v11 offset:28672
    s_waitcnt lgkmcnt(9)
    v_mfma_f32_16x16x32_bf16 v[104:107], v[164:167], v[232:235], v[104:107]
    v_mfma_f32_16x16x32_bf16 v[108:111], v[164:167], v[236:239], v[108:111]
    v_mfma_f32_16x16x32_bf16 v[112:115], v[60:63], v[244:247], v[112:115]
    ds_read_b128 v[232:235], v7 offset:30720
    ds_read_b128 v[236:239], v7 offset:31744
    ds_read_b128 v[244:247], v11 offset:30720
    s_waitcnt lgkmcnt(9)
    v_mfma_f32_16x16x32_bf16 v[104:107], v[168:171], v[88:91], v[104:107]
    v_mfma_f32_16x16x32_bf16 v[108:111], v[168:171], v[92:95], v[108:111]
    v_mfma_f32_16x16x32_bf16 v[112:115], v[64:67], v[216:219], v[112:115]
    ds_read_b32 v88, v12 offset:32768
    ds_read_b32 v89, v12 offset:33024
    ds_read_b32 v90, v12 offset:33280
    ds_read_b32 v91, v12 offset:33536
    ds_read_b32 v92, v12 offset:33792
    ds_read_b32 v93, v12 offset:34048
    ds_read_b32 v94, v12 offset:34304
    ds_read_b32 v95, v12 offset:34560
    ds_read_b32 v216, v13 offset:32768
    ds_read_b32 v217, v13 offset:33024
    ds_read_b32 v218, v13 offset:33280
    ds_read_b32 v219, v13 offset:33536
    s_waitcnt lgkmcnt(15)
    v_mfma_f32_16x16x32_bf16 v[104:107], v[172:175], v[96:99], v[104:107]
    v_mfma_f32_16x16x32_bf16 v[108:111], v[172:175], v[100:103], v[108:111]
    v_mfma_f32_16x16x32_bf16 v[112:115], v[68:71], v[220:223], v[112:115]
    ds_read_b32 v96, v12 offset:34816
    ds_read_b32 v97, v12 offset:35072
    ds_read_b32 v98, v12 offset:35328
    ds_read_b32 v99, v12 offset:35584
    ds_read_b32 v100, v12 offset:35840
    ds_read_b32 v101, v12 offset:36096
    ds_read_b32 v102, v12 offset:36352
    ds_read_b32 v103, v12 offset:36608
    ds_read_b32 v220, v13 offset:34816
    ds_read_b32 v221, v13 offset:35072
    ds_read_b32 v222, v13 offset:35328
    ds_read_b32 v223, v13 offset:35584
    s_waitcnt lgkmcnt(15)
    v_mfma_f32_16x16x32_bf16 v[104:107], v[176:179], v[224:227], v[104:107]
    v_mfma_f32_16x16x32_bf16 v[108:111], v[176:179], v[228:231], v[108:111]
    v_mfma_f32_16x16x32_bf16 v[112:115], v[72:75], v[240:243], v[112:115]
    s_waitcnt lgkmcnt(15)
    v_mfma_f32_16x16x32_bf16 v[104:107], v[180:183], v[232:235], v[104:107]
    v_mfma_f32_16x16x32_bf16 v[108:111], v[180:183], v[236:239], v[108:111]
    v_mfma_f32_16x16x32_bf16 v[112:115], v[76:79], v[244:247], v[112:115]
    s_waitcnt lgkmcnt(12)
    v_mfma_f32_16x16x32_bf16 v[104:107], v[184:187], v[88:91], v[104:107]
    v_mfma_f32_16x16x32_bf16 v[108:111], v[184:187], v[92:95], v[108:111]
    v_mfma_f32_16x16x32_bf16 v[112:115], v[80:83], v[216:219], v[112:115]
    s_waitcnt lgkmcnt(0)
    v_mfma_f32_16x16x32_bf16 v[104:107], v[188:191], v[96:99], v[104:107]
    v_mfma_f32_16x16x32_bf16 v[108:111], v[188:191], v[100:103], v[108:111]
    v_mfma_f32_16x16x32_bf16 v[112:115], v[84:87], v[220:223], v[112:115]
L_odonemm:
    v_mul_u32_u24 v4, 1152, v2
    v_lshl_add_u32 v4, v3, 3, v4
    s_nop 7
    v_fma_f32 v104, v104, v198, v202
    v_fma_f32 v105, v105, v198, v203
    v_fma_f32 v106, v106, v198, v204
    v_fma_f32 v107, v107, v198, v205
    v_cvt_pk_bf16_f32 v88, v104, v105
    v_cvt_pk_bf16_f32 v89, v106, v107
    buffer_store_dwordx2 v[88:89], v4, s[20:23], s30 offen
    v_fma_f32 v108, v108, v199, v206
    v_fma_f32 v109, v109, v199, v207
    v_fma_f32 v110, v110, v199, v208
    v_fma_f32 v111, v111, v199, v209
    v_cvt_pk_bf16_f32 v90, v108, v109
    v_cvt_pk_bf16_f32 v91, v110, v111
    buffer_store_dwordx2 v[90:91], v4, s[20:23], s31 offen
    s_cmp_lt_u32 s10, 2
    s_cbranch_scc0 L_odone
    v_fma_f32 v112, v112, v200, v210
    v_fma_f32 v113, v113, v200, v211
    v_fma_f32 v114, v114, v200, v212
    v_fma_f32 v115, v115, v200, v213
    v_cvt_pk_bf16_f32 v92, v112, v113
    v_cvt_pk_bf16_f32 v93, v114, v115
    buffer_store_dwordx2 v[92:93], v4, s[20:23], s32 offen
L_odone:
    s_cmp_eq_u32 s2, 0
    s_cbranch_scc0 L_noep
    s_mov_b32 s14, 15396864
    s_cmp_eq_u32 s10, 0
    s_cbranch_scc0 L_flag11
    v_mov_b32 v2, s3
    v_mov_b32 v3, 0
    s_mov_b64 s[40:41], exec
    s_mov_b32 exec_lo, 0x1
    s_mov_b32 exec_hi, 0
    buffer_store_dword v2, v3, s[4:7], s14 offen sc1
    s_mov_b64 exec, s[40:41]
L_flag11:
L_noep:
    s_branch L_end
L_hk0:
    s_mov_b32 m0, s63
    s_add_u32 s63, s63, 8192
    buffer_load_dwordx4 v119, s[4:7], s62 offen lds
    s_add_u32 s62, s62, 8192
    s_mov_b32 m0, s63
    s_add_u32 s63, s63, 8192
    buffer_load_dwordx4 v119, s[4:7], s62 offen lds
    s_add_u32 s62, s62, 8192
    s_mov_b32 m0, s63
    s_add_u32 s63, s63, 8192
    buffer_load_dwordx4 v119, s[4:7], s62 offen lds
    s_add_u32 s62, s62, 8192
    s_branch L_hr0
L_hk1:
    s_mul_i32 s24, s97, 9
    s_add_u32 s24, s24, s10
    s_lshl_b32 s24, s24, 10
    s_add_u32 s24, s24, 14704640
    buffer_load_dwordx4 v[120:123], v119, s[4:7], s24 offen
    s_add_u32 s24, s24, 36864
    buffer_load_dwordx4 v[124:127], v119, s[4:7], s24 offen
    s_add_u32 s24, s24, 36864
    buffer_load_dwordx4 v[128:131], v119, s[4:7], s24 offen
    s_add_u32 s24, s24, 36864
    buffer_load_dwordx4 v[132:135], v119, s[4:7], s24 offen
    s_add_u32 s24, s24, 36864
    buffer_load_dwordx4 v[136:139], v119, s[4:7], s24 offen
    s_add_u32 s24, s24, 36864
    buffer_load_dwordx4 v[140:143], v119, s[4:7], s24 offen
    s_branch L_hr1
L_hk2:
    s_mov_b32 m0, s63
    s_add_u32 s63, s63, 8192
    buffer_load_dwordx4 v119, s[4:7], s62 offen lds
    s_add_u32 s62, s62, 8192
    s_mov_b32 m0, s63
    s_add_u32 s63, s63, 8192
    buffer_load_dwordx4 v119, s[4:7], s62 offen lds
    s_add_u32 s62, s62, 8192
    s_mov_b32 m0, s63
    s_add_u32 s63, s63, 8192
    buffer_load_dwordx4 v119, s[4:7], s62 offen lds
    s_add_u32 s62, s62, 8192
    s_branch L_hr2
L_hk3:
    s_mul_i32 s24, s97, 9
    s_add_u32 s24, s24, s10
    s_lshl_b32 s24, s24, 10
    s_add_u32 s24, s24, 14925824
    buffer_load_dwordx4 v[144:147], v119, s[4:7], s24 offen
    s_add_u32 s24, s24, 36864
    buffer_load_dwordx4 v[148:151], v119, s[4:7], s24 offen
    s_add_u32 s24, s24, 36864
    buffer_load_dwordx4 v[152:155], v119, s[4:7], s24 offen
    s_add_u32 s24, s24, 36864
    buffer_load_dwordx4 v[156:159], v119, s[4:7], s24 offen
    s_add_u32 s24, s24, 36864
    buffer_load_dwordx4 v[160:163], v119, s[4:7], s24 offen
    s_add_u32 s24, s24, 36864
    buffer_load_dwordx4 v[164:167], v119, s[4:7], s24 offen
    s_branch L_hr3
L_hk4:
    s_mov_b32 m0, s63
    s_add_u32 s63, s63, 8192
    buffer_load_dwordx4 v119, s[4:7], s62 offen lds
    s_add_u32 s62, s62, 8192
    s_mov_b32 m0, s63
    s_add_u32 s63, s63, 8192
    buffer_load_dwordx4 v119, s[4:7], s62 offen lds
    s_add_u32 s62, s62, 8192
    s_mov_b32 m0, s63
    s_add_u32 s63, s63, 8192
    buffer_load_dwordx4 v119, s[4:7], s62 offen lds
    s_add_u32 s62, s62, 8192
    s_branch L_hr4
L_hk5:
    s_mul_i32 s24, s97, 9
    s_add_u32 s24, s24, s10
    s_lshl_b32 s24, s24, 10
    s_add_u32 s24, s24, 15147008
    buffer_load_dwordx4 v[168:171], v119, s[4:7], s24 offen
    s_add_u32 s24, s24, 36864
    buffer_load_dwordx4 v[172:175], v119, s[4:7], s24 offen
    s_add_u32 s24, s24, 36864
    buffer_load_dwordx4 v[176:179], v119, s[4:7], s24 offen
    s_add_u32 s24, s24, 36864
    buffer_load_dwordx4 v[180:183], v119, s[4:7], s24 offen
    s_add_u32 s24, s24, 36864
    buffer_load_dwordx4 v[184:187], v119, s[4:7], s24 offen
    s_add_u32 s24, s24, 36864
    buffer_load_dwordx4 v[188:191], v119, s[4:7], s24 offen
    s_branch L_hr5
L_hk6:
    s_cmp_eq_u32 s23, 2
    s_cbranch_scc1 L_w_j
    s_mov_b32 m0, s63
    s_add_u32 s63, s63, 8192
    buffer_load_dwordx4 v119, s[4:7], s62 offen lds
    s_add_u32 s62, s62, 8192
    s_mov_b32 m0, s63
    s_add_u32 s63, s63, 8192
    buffer_load_dwordx4 v119, s[4:7], s62 offen lds
    s_add_u32 s62, s62, 8192
    s_branch L_hr6
L_w_j:
    v_mov_b32 v2, 163648
L_w_spin:
    ds_read_b128 v[224:227], v2
    ds_read_b128 v[228:231], v2 offset:16
    s_waitcnt lgkmcnt(0)
    v_and_b32 v224, v224, v225
    v_and_b32 v226, v226, v227
    v_and_b32 v228, v228, v229
    v_and_b32 v230, v230, v231
    v_and_b32 v224, v224, v226
    v_and_b32 v228, v228, v230
    v_and_b32 v224, v224, v228
    s_nop 0
    v_readfirstlane_b32 s14, v224
    s_cmp_eq_u32 s14, 1
    s_cbranch_scc0 L_w_spin
    s_lshl_b32 s14, s2, 2
    s_add_u32 s14, s14, 15380480
    s_cmp_eq_u32 s10, 0
    s_cbranch_scc0 L_flag8
    v_mov_b32 v2, s3
    v_mul_u32_u24 v3, 1024, v1
    s_mov_b64 s[40:41], exec
    s_mov_b32 exec_lo, 0xff
    s_mov_b32 exec_hi, 0
    buffer_store_dword v2, v3, s[4:7], s14 offen sc1
    s_mov_b64 exec, s[40:41]
L_flag8:
    s_branch L_hr6
L_hk7:
    s_mov_b32 s44, s64
    s_mov_b32 s45, s65
    s_mov_b32 s46, 2359296
    s_mov_b32 s47, 0x20000
    v_and_b32 v2, 15, v1
    v_lshrrev_b32 v3, 4, v1
    v_mul_u32_u24 v4, 1152, v2
    v_lshl_add_u32 v4, v3, 3, v4
    s_mul_i32 s28, s96, 1152
    s_mul_i32 s29, s97, 288
    s_add_u32 s28, s28, s29
    s_lshl_b32 s29, s10, 5
    s_add_u32 s29, s29, s28
    buffer_load_dwordx2 v[192:193], v4, s[44:47], s29 offen
    s_add_u32 s29, s29, 18432
    buffer_load_dwordx2 v[194:195], v4, s[44:47], s29 offen
    s_mul_i32 s29, s10, 18432
    s_add_u32 s29, s29, s28
    s_add_u32 s29, s29, 256
    buffer_load_dwordx2 v[196:197], v4, s[44:47], s29 offen
    s_branch L_hr7
L_hs7:
    s_waitcnt vmcnt(0)
    s_lshl_b32 s14, s10, 2
    v_mov_b32 v2, s14
    v_add_u32 v2, 163648, v2
    v_mov_b32 v3, 1
    ds_write_b32 v2, v3
    s_branch L_hr7
L_fb:
    s_mov_b32 s22, 11
L_dmafb:
    s_mov_b32 m0, s63
    s_add_u32 s63, s63, 8192
    buffer_load_dwordx4 v119, s[4:7], s62 offen lds
    s_add_u32 s62, s62, 8192
    s_sub_u32 s22, s22, 1
    s_cmp_lg_u32 s22, 0
    s_cbranch_scc1 L_dmafb
    s_waitcnt vmcnt(0)
    s_barrier
    v_mov_b32 v117, 0
    v_mov_b32 v2, 0xff800000
    v_mov_b32 v3, v23
    v_mov_b32 v4, v24
    s_mov_b32 s23, 64
L_fbl:
    ds_read_b128 v[16:19], v3
    ds_read_b32 v20, v4
    s_waitcnt lgkmcnt(0)
    v_mfma_f32_32x32x16_bf16 v[48:63], v[16:19], v[112:115], 0
    s_nop 15
    v_mfma_f32_32x32x8bf16_1k v[48:63], v[20:21], v[116:117], v[48:63]
    v_add_u32 v3, 2432, v3
    v_add_u32 v4, 2432, v4
    s_nop 15
    v_max3_f32 v2, v48, v49, v2
    v_max3_f32 v2, v50, v51, v2
    v_max3_f32 v2, v52, v53, v2
    v_max3_f32 v2, v54, v55, v2
    v_max3_f32 v2, v56, v57, v2
    v_max3_f32 v2, v58, v59, v2
    v_max3_f32 v2, v60, v61, v2
    v_max3_f32 v2, v62, v63, v2
    s_sub_u32 s23, s23, 1
    s_cmp_lg_u32 s23, 0
    s_cbranch_scc1 L_fbl
    v_mov_b32 v3, v2
    s_nop 1
    v_permlane32_swap_b32 v2, v3
    s_nop 1
    v_max_f32 v2, v2, v3
    v_sub_f32 v2, 0, v2
    v_and_b32 v3, 0xffff0000, v2
    v_sub_f32 v2, v2, v3
    v_and_b32 v4, 0xffff0000, v2
    v_sub_f32 v2, v2, v4
    v_lshrrev_b32 v2, 16, v2
    v_lshrrev_b32 v3, 16, v3
    v_or_b32 v3, v3, v4
    v_cmp_gt_u32 vcc, 32, v1
    s_nop 1
    v_cndmask_b32 v117, v2, v3, vcc
    s_sub_u32 s62, s62, 90112
    s_sub_u32 s63, s63, 90112
    ds_read_b128 v[16:19], v23 offset:0
    ds_read_b32 v20, v24
    s_waitcnt lgkmcnt(0)
    s_branch L_fbret
L_end:
    s_endpgm
.section .rodata,"a"
.p2align 6
.amdhsa_kernel gated_mix__mha_block__ssm_conv_h3__prompt_kernel
  .amdhsa_next_free_vgpr 256
  .amdhsa_next_free_sgpr 102
  .amdhsa_accum_offset 256
  .amdhsa_group_segment_fixed_size 0
  .amdhsa_kernarg_size 104
  .amdhsa_user_sgpr_count 2
  .amdhsa_user_sgpr_kernarg_segment_ptr 1
  .amdhsa_system_sgpr_workgroup_id_x 1
.end_amdhsa_kernel
```
